```python
import torch

def _softmax(x, axis=-1):
    return torch.softmax(x, dim=axis)
def _gelu(x):
    return torch.nn.functional.gelu(x, approximate="tanh")
def _silu(x):
    return torch.nn.functional.silu(x)
def _sigmoid(x):
    return torch.sigmoid(x)
def _layernorm(x, axis=-1, eps=1e-5):
    m = x.mean(dim=axis, keepdim=True)
    v = x.var(dim=axis, keepdim=True, unbiased=False)
    return (x - m) / torch.sqrt(v + eps)
def _scatter_add(tgt, idx, src, axis=0):
    return tgt.clone().index_add_(axis, idx, src)
def _segment_sum(src, seg, n):
    out = torch.zeros((n,) + src.shape[1:], dtype=src.dtype)
    return out.index_add_(0, seg, src)
def _pad(x, pw):
    flat = tuple(v for pair in reversed(pw) for v in pair)
    return torch.nn.functional.pad(x, flat)

kernel_name = 'gated_mix__ssm_conv_s5__glu_gated_glu__prompt'

def setup_inputs():

    _w = (lambda a: (lambda t: t.to(torch.bfloat16) if t.is_floating_point() else t)(torch.as_tensor(a)))
    def _A_setup():
        B, S, D = 1, 2048, 512
        P = D
        Lambda_re = -0.5 * (lambda _x: torch.exp(torch.as_tensor(_x)))((lambda *s: torch.randn(*s, dtype=torch.bfloat16) * 0.4)(P))
        Lambda_im = (lambda *s: torch.randn(*s, dtype=torch.bfloat16) * 0.8)(P) * 1.0
        B_re = (lambda *s: torch.randn(*s, dtype=torch.bfloat16) * 0.8)(P, D) * (D ** -0.5)
        B_im = (lambda *s: torch.randn(*s, dtype=torch.bfloat16) * 0.8)(P, D) * (D ** -0.5)
        C_re = (lambda *s: torch.randn(*s, dtype=torch.bfloat16) * 0.8)(D, P) * (P ** -0.5)
        C_im = (lambda *s: torch.randn(*s, dtype=torch.bfloat16) * 0.8)(D, P) * (P ** -0.5)
        log_dt = (lambda *s: torch.randn(*s, dtype=torch.bfloat16) * 0.4)(P) * 0.3 - 2.0
        Dskip = (lambda *s: torch.randn(*s, dtype=torch.bfloat16) * 0.1)(D)
        return {
            "x": _w((lambda *s: torch.randn(*s, dtype=torch.bfloat16) * 0.05)(B, S, D)),
            "Lambda_re": _w(Lambda_re),
            "Lambda_im": _w(Lambda_im),
            "B_re": _w(B_re),
            "B_im": _w(B_im),
            "C_re": _w(C_re),
            "C_im": _w(C_im),
            "log_dt": _w(log_dt),
            "Dskip": _w(Dskip),
        }
    _A_in = _A_setup()

    def _B_setup():
        B, S, D, F = 1, 2048, 512, 1792
        return {
            "x": _w((lambda *s: torch.randn(*s, dtype=torch.bfloat16) * 0.05)(B, S, D)),
            "w_gate": _w((lambda *s: torch.randn(*s, dtype=torch.bfloat16) * 0.4)(D, F)),
            "w_up": _w((lambda *s: torch.randn(*s, dtype=torch.bfloat16) * 0.05)(D, F)),
            "w_down": _w((lambda *s: torch.randn(*s, dtype=torch.bfloat16) * 0.05)(F, D)),
        }
    _B_in = _B_setup()

    return {
        "A_x": _A_in["x"],
        "A_Lambda_re": _A_in["Lambda_re"],
        "A_Lambda_im": _A_in["Lambda_im"],
        "A_B_re": _A_in["B_re"],
        "A_B_im": _A_in["B_im"],
        "A_C_re": _A_in["C_re"],
        "A_C_im": _A_in["C_im"],
        "A_log_dt": _A_in["log_dt"],
        "A_Dskip": _A_in["Dskip"],
        "B_x": _B_in["x"],
        "B_w_gate": _B_in["w_gate"],
        "B_w_up": _B_in["w_up"],
        "B_w_down": _B_in["w_down"],
        "gate_w": _w((lambda *s: torch.randn(*s, dtype=torch.bfloat16) * 0.05)(512) * 16.0),
    }

def reference(A_x, A_Lambda_re, A_Lambda_im, A_B_re, A_B_im, A_C_re, A_C_im, A_log_dt, A_Dskip, B_x, B_w_gate, B_w_up, B_w_down, gate_w):
    def _A_ref(x, Lambda_re, Lambda_im, B_re, B_im, C_re, C_im, log_dt, Dskip):
        Bsz, L, H = x.shape
        Lam = Lambda_re + 1j * Lambda_im
        Bmat = B_re + 1j * B_im
        Cmat = C_re + 1j * C_im
        dt = torch.exp(log_dt)
        Lam_bar = torch.exp(dt * Lam)
        B_bar = ((Lam_bar - 1.0) / Lam)[:, None] * Bmat
        Bu = torch.einsum("bld,pd->blp", x + 0j, B_bar)
        h = torch.zeros_like(Bu[:, 0, :])
        hs = []
        for t in range(L):
            h = Lam_bar[None, :] * h + Bu[:, t, :]
            hs.append(h)
        hseq = torch.stack(hs, 1)
        y = 2.0 * torch.einsum("blp,dp->bld", hseq, Cmat).real + x * Dskip[None, None, :]
        return y

    def _B_ref(x, w_gate, w_up, w_down):
        g = torch.einsum("bsd,df->bsf", x, w_gate)
        u = torch.einsum("bsd,df->bsf", x, w_up)
        h = _sigmoid(g) * u
        return torch.einsum("bsf,fd->bsd", h, w_down)

    x = A_x
    g = _sigmoid((x * gate_w).sum(-1, keepdims=True))
    a = _A_ref(x, A_Lambda_re, A_Lambda_im, A_B_re, A_B_im, A_C_re, A_C_im, A_log_dt, A_Dskip)
    b = _B_ref(x, B_w_gate, B_w_up, B_w_down)
    return g * a + (1 - g) * b
```

```asm
; @launch grid=(256,1,1) block=(512,1,1) lds=163840
.amdgcn_target "amdgcn-amd-amdhsa--gfx950"
.text
.globl gated_mix__ssm_conv_s5__glu_gated_glu__prompt_kernel
.p2align 8
.type gated_mix__ssm_conv_s5__glu_gated_glu__prompt_kernel,@function
gated_mix__ssm_conv_s5__glu_gated_glu__prompt_kernel:
    s_cmp_ge_u32 s2, 256
    s_cbranch_scc1 K1_END
    s_load_dwordx16 s[8:23], s[0:1], 0
    s_load_dwordx16 s[24:39], s[0:1], 64
    s_load_dwordx2 s[40:41], s[0:1], 128
    v_lshrrev_b32 v116, 6, v0
    v_and_b32 v1, 63, v0
    s_and_b32 s100, s2, 7
    v_readfirstlane_b32 s7, v116
    s_lshr_b32 s101, s2, 3
    s_lshr_b32 s94, s101, 2
    s_and_b32 s95, s101, 3
    s_lshr_b32 s5, s101, 1
    s_lshl_b32 s6, s100, 1
    s_and_b32 s99, s101, 1
    s_add_u32 s6, s6, s99
    s_add_u32 s3, s94, s95
    s_and_b32 s3, s3, 0
    s_and_b32 s42, s7, 3
    s_lshr_b32 s43, s7, 2
    v_lshrrev_b32 v120, 3, v1
    v_and_b32 v121, 7, v1
    s_lshl_b32 s99, s5, 17
    s_lshr_b32 s100, s7, 1
    s_lshl_b32 s100, s100, 15
    s_add_u32 s99, s99, s100
    s_and_b32 s100, s7, 1
    s_lshl_b32 s101, s100, 13
    s_add_u32 s99, s99, s101
    v_lshrrev_b32 v116, 1, v120
    v_xor_b32 v117, v121, v116
    v_lshlrev_b32 v117, 4, v117
    v_lshrrev_b32 v118, 2, v120
    v_lshlrev_b32 v118, 14, v118
    v_and_b32 v119, 3, v120
    v_lshl_add_u32 v118, v119, 10, v118
    v_add3_u32 v4, v118, v117, s99
    v_xor_b32 v5, 64, v4
    v_add_u32 v5, 0x1000, v5
    s_lshl_b32 s101, s100, 6
    v_xor_b32 v117, s101, v117
    s_lshl_b32 s99, s6, 15
    s_lshl_b32 s101, s42, 13
    s_add_u32 s99, s99, s101
    v_lshl_add_u32 v6, v120, 10, v117
    v_add_u32 v6, s99, v6
    v_lshrrev_b32 v116, 1, v121
    v_bfe_u32 v117, v120, 1, 1
    v_xor_b32 v116, v116, v117
    v_lshlrev_b32 v116, 5, v116
    v_and_b32 v117, 1, v121
    v_lshl_add_u32 v116, v117, 4, v116
    v_mul_u32_u24 v117, 3584, v120
    s_mul_i32 s99, s7, 28672
    s_lshl_b32 s100, s6, 7
    s_add_u32 s99, s99, s100
    v_add3_u32 v7, v116, v117, s99
    v_xor_b32 v8, 64, v7
    s_lshl_b32 s4, s6, 2
    s_add_u32 s4, s4, s5
    s_and_b32 s4, s4, 7
    s_lshl_b32 s96, s7, 11
    s_lshl_b32 s97, s7, 10
    s_mov_b32 s46, 0x200000
    s_mov_b32 s47, 0x00020000
    s_mov_b32 s50, 0x80000
    s_mov_b32 s51, 0x00020000
    s_mov_b32 s54, 0x1c0000
    s_mov_b32 s55, 0x00020000
    s_mov_b32 s58, 0x1c0000
    s_mov_b32 s59, 0x00020000
    s_waitcnt lgkmcnt(0)
    s_mov_b32 s44, s8
    s_mov_b32 s45, s9
    s_cmp_eq_u32 s43, 0
    s_cselect_b32 s48, s14, s16
    s_cselect_b32 s49, s15, s17
    s_mov_b32 s52, s28
    s_mov_b32 s53, s29
    s_mov_b32 s56, s30
    s_mov_b32 s57, s31
    s_add_u32 s85, s4, 0
    s_and_b32 s85, s85, 7
    s_lshl_b32 s87, s85, 7
    s_mul_i32 s85, s85, 229376
    s_add_u32 m0, s96, 0
    s_add_u32 s93, s87, 0
    buffer_load_dwordx4 v4, s[44:47], s93 offen lds
    s_add_u32 m0, s97, 24576
    s_add_u32 s93, s85, 0
    buffer_load_dwordx4 v7, s[52:55], s93 offen lds
    s_add_u32 m0, s96, 1024
    s_add_u32 s93, s87, 0
    buffer_load_dwordx4 v5, s[44:47], s93 offen lds
    s_add_u32 m0, s97, 32768
    s_add_u32 s93, s85, 0
    buffer_load_dwordx4 v8, s[56:59], s93 offen lds
    s_add_u32 m0, s97, 16384
    s_add_u32 s93, s87, 0
    buffer_load_dwordx4 v6, s[48:51], s93 offen lds
    v_and_b32 v116, 31, v1
    v_lshrrev_b32 v117, 5, v1
    v_bfe_u32 v118, v1, 1, 3
    v_xor_b32 v118, v118, v117
    v_lshlrev_b32 v118, 4, v118
    v_lshl_add_u32 v118, v116, 7, v118
    s_lshl_b32 s99, s42, 12
    v_add_u32 v10, s99, v118
    v_xor_b32 v11, 32, v10
    v_xor_b32 v12, 64, v10
    v_xor_b32 v13, 96, v10
    v_lshlrev_b32 v14, 4, v1
    v_bfe_u32 v116, v1, 2, 2
    v_lshl_add_u32 v116, v117, 3, v116
    v_bfe_u32 v117, v1, 4, 1
    v_and_b32 v119, 3, v1
    v_lshlrev_b32 v119, 3, v119
    v_lshlrev_b32 v17, 13, v117
    v_lshl_add_u32 v17, v116, 7, v17
    v_bfe_u32 v118, v1, 3, 2
    v_lshl_add_u32 v17, v118, 5, v17
    v_add_u32 v17, v17, v119
    v_add_u32 v17, 24576, v17
    v_mul_u32_u24 v16, 12416, v117
    v_mul_u32_u24 v118, 96, v116
    v_add3_u32 v16, v16, v118, v119
    s_barrier
    s_cmp_eq_u32 s43, 0
    s_cbranch_scc0 K1_ROLE1
    s_lshl_b32 s99, s42, 12
    s_sub_u32 s99, 16384, s99
    v_add_u32 v18, s99, v10
    v_add_u32 v19, s99, v11
    v_add_u32 v20, s99, v12
    v_add_u32 v21, s99, v13
    s_mov_b32 s60, s16
    s_mov_b32 s61, s17
    s_mov_b32 s62, 0x80000
    s_mov_b32 s63, 0x00020000
    s_add_u32 s85, s4, 1
    s_and_b32 s85, s85, 7
    s_lshl_b32 s87, s85, 7
    s_mul_i32 s85, s85, 229376
    s_add_u32 m0, s96, 40960
    s_add_u32 s93, s87, 0
    buffer_load_dwordx4 v4, s[44:47], s93 offen lds
    s_add_u32 m0, s97, 65536
    s_add_u32 s93, s85, 0
    buffer_load_dwordx4 v7, s[52:55], s93 offen lds
    s_add_u32 m0, s96, 41984
    s_add_u32 s93, s87, 0
    buffer_load_dwordx4 v5, s[44:47], s93 offen lds
    s_add_u32 m0, s97, 73728
    s_add_u32 s93, s85, 0
    buffer_load_dwordx4 v8, s[56:59], s93 offen lds
    s_add_u32 m0, s97, 57344
    s_add_u32 s93, s87, 0
    buffer_load_dwordx4 v6, s[48:51], s93 offen lds
    s_add_u32 m0, s96, 49152
    s_add_u32 s93, s87, 65536
    buffer_load_dwordx4 v4, s[44:47], s93 offen lds
    s_add_u32 m0, s97, 69632
    s_add_u32 s93, s85, 114688
    buffer_load_dwordx4 v7, s[52:55], s93 offen lds
    s_add_u32 m0, s96, 50176
    s_add_u32 s93, s87, 65536
    buffer_load_dwordx4 v5, s[44:47], s93 offen lds
    s_add_u32 m0, s97, 77824
    s_add_u32 s93, s85, 114688
    buffer_load_dwordx4 v8, s[56:59], s93 offen lds
    s_add_u32 m0, s97, 61440
    s_add_u32 s93, s87, 0
    buffer_load_dwordx4 v6, s[60:63], s93 offen lds
    s_waitcnt vmcnt(10)
    s_barrier
    ds_read_b128 a[0:3], v10 offset:0
    ds_read_b128 v[88:91], v18 offset:0
    ds_read_b128 v[92:95], v18 offset:4096
    ds_read_b64_tr_b16 v[96:97], v17 offset:0
    ds_read_b64_tr_b16 v[98:99], v17 offset:512
    ds_read_b128 a[4:7], v11 offset:0
    ds_read_b128 v[100:103], v19 offset:0
    ds_read_b128 v[104:107], v19 offset:4096
    ds_read_b64_tr_b16 v[108:109], v17 offset:2048
    ds_read_b64_tr_b16 v[110:111], v17 offset:2560
    s_waitcnt lgkmcnt(5)
    v_mfma_f32_32x32x16_bf16 v[24:39], a[0:3], v[88:91], 0
    ds_read_b128 a[8:11], v12 offset:0
    ds_read_b128 v[88:91], v20 offset:0
    s_add_u32 s85, s4, 2
    s_and_b32 s85, s85, 7
    s_lshl_b32 s87, s85, 7
    s_mul_i32 s85, s85, 229376
    s_add_u32 m0, s96, 81920
    s_add_u32 s93, s87, 0
    buffer_load_dwordx4 v4, s[44:47], s93 offen lds
    s_add_u32 m0, s97, 106496
    s_add_u32 s93, s85, 0
    buffer_load_dwordx4 v7, s[52:55], s93 offen lds
    s_add_u32 m0, s96, 82944
    s_add_u32 s93, s87, 0
    buffer_load_dwordx4 v5, s[44:47], s93 offen lds
    s_add_u32 m0, s97, 114688
    s_add_u32 s93, s85, 0
    buffer_load_dwordx4 v8, s[56:59], s93 offen lds
    v_mfma_f32_32x32x16_bf16 v[40:55], a[0:3], v[92:95], 0
    ds_read_b128 v[92:95], v20 offset:4096
    s_add_u32 m0, s97, 98304
    s_add_u32 s93, s87, 0
    buffer_load_dwordx4 v6, s[48:51], s93 offen lds
    v_mfma_f32_32x32x16_bf16 v[56:71], v[96:99], a[0:3], 0
    ds_read_b64_tr_b16 v[96:97], v17 offset:4096
    ds_read_b64_tr_b16 v[98:99], v17 offset:4608
    s_waitcnt lgkmcnt(5)
    v_mfma_f32_32x32x16_bf16 v[24:39], a[4:7], v[100:103], v[24:39]
    ds_read_b128 a[12:15], v13 offset:0
    ds_read_b128 v[100:103], v21 offset:0
    s_and_b32 s99, s2, 7
    s_lshr_b32 s26, s99, 2
    s_lshl_b32 s26, s26, 1
    s_and_b32 s100, s99, 1
    s_add_u32 s26, s26, s100
    s_lshl_b32 s26, s26, 3
    s_add_u32 s26, s26, s94
    s_bfe_u32 s27, s99, 0x10001
    s_lshl_b32 s27, s27, 2
    s_add_u32 s27, s27, s95
    s_mul_i32 s98, s42, 3072
    s_mov_b32 s64, s40
    s_mov_b32 s65, s41
    s_mov_b32 s66, 0x1400000
    s_mov_b32 s67, 0x00020000
    s_mov_b32 s92, 0xbfb8aa3b
    s_lshl_b32 s99, s5, 1
    s_lshr_b32 s100, s42, 1
    s_add_u32 s99, s99, s100
    s_mul_i32 s99, s99, 360448
    s_and_b32 s100, s42, 1
    s_lshl_b32 s100, s100, 10
    s_add_u32 s99, s99, s100
    s_lshl_b32 s100, s6, 13
    s_add_u32 s94, s99, s100
    s_add_u32 s84, s94, 131072
    s_mul_i32 s100, s6, 6144
    s_add_u32 s95, s99, s100
    s_add_u32 s95, s95, 262144
    s_mov_b32 s72, s38
    s_mov_b32 s73, s39
    s_mov_b32 s74, 0x100
    s_mov_b32 s75, 0x00020000
    v_lshrrev_b32 v118, 5, v1
    s_lshl_b32 s99, s42, 9
    s_add_u32 s99, s99, 35072
    v_and_b32 v116, 31, v1
    v_lshlrev_b32 v22, 8, v118
    v_lshl_add_u32 v22, v116, 3, v22
    v_add_u32 v22, s99, v22
    s_or_b32 s99, s5, s6
    s_xor_b32 s100, s42, 3
    s_or_b32 s99, s99, s100
    s_cmp_eq_u32 s99, 0
    s_cbranch_scc0 K1_NOLEAD
    s_memrealtime s[0:1]
    s_waitcnt lgkmcnt(0)
    s_or_b32 s0, s0, 1
    v_mov_b32 v114, s0
    v_mov_b32 v115, s1
    s_mov_b64 exec, 1
    buffer_store_dwordx2 v[114:115], off, s[72:75], 0 sc1
    s_mov_b64 exec, -1
K1_NOLEAD:
    s_mov_b32 s76, s10
    s_mov_b32 s77, s11
    s_mov_b32 s78, 0x400
    s_mov_b32 s79, 0x00020000
    s_mov_b32 s80, s12
    s_mov_b32 s81, s13
    s_mov_b32 s82, 0x400
    s_mov_b32 s83, 0x00020000
    s_mov_b32 s88, s22
    s_mov_b32 s89, s23
    s_mov_b32 s90, 0x400
    s_mov_b32 s91, 0x00020000
    v_and_b32 v116, 31, v1
    s_lshl_b32 s99, s6, 6
    v_lshl_add_u32 v116, v116, 1, s99
    buffer_load_ushort v126, v116, s[76:79], 0 offen
    buffer_load_ushort v127, v116, s[80:83], 0 offen
    buffer_load_ushort v86, v116, s[88:91], 0 offen
    v_mfma_f32_32x32x16_bf16 v[40:55], a[4:7], v[104:107], v[40:55]
    ds_read_b128 v[104:107], v21 offset:4096
    s_lshl_b32 s99, s5, 7
    s_lshl_b32 s100, s6, 3
    s_add_u32 s99, s99, s100
    s_lshl_b32 s100, s42, 1
    s_add_u32 s11, s99, s100
    s_lshl_b32 s99, s11, 10
    buffer_load_dwordx4 v[72:75], v14, s[44:47], s99 offen
    buffer_load_dwordx4 v[76:79], v14, s[44:47], s99 offen offset:1024
    s_mov_b32 s76, s34
    s_mov_b32 s77, s35
    s_mov_b32 s78, 0x400
    s_mov_b32 s79, 0x00020000
    buffer_load_dwordx4 v[80:83], v14, s[76:79], 0 offen
    v_mfma_f32_32x32x16_bf16 v[56:71], v[108:111], a[4:7], v[56:71]
    ds_read_b64_tr_b16 v[108:109], v17 offset:6144
    ds_read_b64_tr_b16 v[110:111], v17 offset:6656
    s_waitcnt vmcnt(11)
    s_barrier
    s_waitcnt lgkmcnt(5)
    v_mfma_f32_32x32x16_bf16 v[24:39], a[8:11], v[88:91], v[24:39]
    ds_read_b128 a[16:19], v10 offset:40960
    ds_read_b128 v[88:91], v18 offset:40960
    s_add_u32 s85, s4, 3
    s_and_b32 s85, s85, 7
    s_lshl_b32 s87, s85, 7
    s_mul_i32 s85, s85, 229376
    s_add_u32 m0, s96, 122880
    s_add_u32 s93, s87, 0
    buffer_load_dwordx4 v4, s[44:47], s93 offen lds
    s_add_u32 m0, s97, 147456
    s_add_u32 s93, s85, 0
    buffer_load_dwordx4 v7, s[52:55], s93 offen lds
    s_add_u32 m0, s96, 123904
    s_add_u32 s93, s87, 0
    buffer_load_dwordx4 v5, s[44:47], s93 offen lds
    s_add_u32 m0, s97, 155648
    s_add_u32 s93, s85, 0
    buffer_load_dwordx4 v8, s[56:59], s93 offen lds
    v_mfma_f32_32x32x16_bf16 v[40:55], a[8:11], v[92:95], v[40:55]
    ds_read_b128 v[92:95], v18 offset:45056
    s_add_u32 m0, s97, 139264
    s_add_u32 s93, s87, 0
    buffer_load_dwordx4 v6, s[48:51], s93 offen lds
    v_mfma_f32_32x32x16_bf16 v[56:71], v[96:99], a[8:11], v[56:71]
    ds_read_b64_tr_b16 v[96:97], v17 offset:40960
    ds_read_b64_tr_b16 v[98:99], v17 offset:41472
    s_waitcnt lgkmcnt(5)
    v_mfma_f32_32x32x16_bf16 v[24:39], a[12:15], v[100:103], v[24:39]
    ds_read_b128 a[20:23], v11 offset:40960
    ds_read_b128 v[100:103], v19 offset:40960
    v_mfma_f32_32x32x16_bf16 v[40:55], a[12:15], v[104:107], v[40:55]
    ds_read_b128 v[104:107], v19 offset:45056
    v_mfma_f32_32x32x16_bf16 v[56:71], v[108:111], a[12:15], v[56:71]
    ds_read_b64_tr_b16 v[108:109], v17 offset:43008
    ds_read_b64_tr_b16 v[110:111], v17 offset:43520
    s_waitcnt lgkmcnt(5)
    v_mfma_f32_32x32x16_bf16 v[24:39], a[16:19], v[88:91], v[24:39]
    ds_read_b128 a[24:27], v12 offset:40960
    ds_read_b128 v[88:91], v20 offset:40960
    v_mfma_f32_32x32x16_bf16 v[40:55], a[16:19], v[92:95], v[40:55]
    ds_read_b128 v[92:95], v20 offset:45056
    v_mfma_f32_32x32x16_bf16 v[56:71], v[96:99], a[16:19], v[56:71]
    ds_read_b64_tr_b16 v[96:97], v17 offset:45056
    ds_read_b64_tr_b16 v[98:99], v17 offset:45568
    s_waitcnt lgkmcnt(5)
    v_mfma_f32_32x32x16_bf16 v[24:39], a[20:23], v[100:103], v[24:39]
    ds_read_b128 a[28:31], v13 offset:40960
    ds_read_b128 v[100:103], v21 offset:40960
    v_mfma_f32_32x32x16_bf16 v[40:55], a[20:23], v[104:107], v[40:55]
    ds_read_b128 v[104:107], v21 offset:45056
    v_mfma_f32_32x32x16_bf16 v[56:71], v[108:111], a[20:23], v[56:71]
    ds_read_b64_tr_b16 v[108:109], v17 offset:47104
    ds_read_b64_tr_b16 v[110:111], v17 offset:47616
    s_waitcnt vmcnt(11)
    s_barrier
    s_waitcnt lgkmcnt(5)
    v_mfma_f32_32x32x16_bf16 v[24:39], a[24:27], v[88:91], v[24:39]
    v_add_u32 v10, 81920, v10
    v_add_u32 v11, 81920, v11
    v_add_u32 v12, 81920, v12
    v_add_u32 v13, 81920, v13
    v_add_u32 v18, 81920, v18
    v_add_u32 v19, 81920, v19
    v_add_u32 v20, 81920, v20
    v_add_u32 v21, 81920, v21
    v_add_u32 v17, 81920, v17
    ds_read_b128 a[32:35], v10 offset:0
    ds_read_b128 v[88:91], v18 offset:0
    s_add_u32 s85, s4, 4
    s_and_b32 s85, s85, 7
    s_lshl_b32 s87, s85, 7
    s_mul_i32 s85, s85, 229376
    s_add_u32 m0, s96, 0
    s_add_u32 s93, s87, 0
    buffer_load_dwordx4 v4, s[44:47], s93 offen lds
    s_add_u32 m0, s97, 24576
    s_add_u32 s93, s85, 0
    buffer_load_dwordx4 v7, s[52:55], s93 offen lds
    s_add_u32 m0, s96, 1024
    s_add_u32 s93, s87, 0
    buffer_load_dwordx4 v5, s[44:47], s93 offen lds
    s_add_u32 m0, s97, 32768
    s_add_u32 s93, s85, 0
    buffer_load_dwordx4 v8, s[56:59], s93 offen lds
    v_mfma_f32_32x32x16_bf16 v[40:55], a[24:27], v[92:95], v[40:55]
    ds_read_b128 v[92:95], v18 offset:4096
    s_add_u32 m0, s97, 16384
    s_add_u32 s93, s87, 0
    buffer_load_dwordx4 v6, s[48:51], s93 offen lds
    v_mfma_f32_32x32x16_bf16 v[56:71], v[96:99], a[24:27], v[56:71]
    ds_read_b64_tr_b16 v[96:97], v17 offset:0
    ds_read_b64_tr_b16 v[98:99], v17 offset:512
    s_waitcnt lgkmcnt(5)
    v_mfma_f32_32x32x16_bf16 v[24:39], a[28:31], v[100:103], v[24:39]
    ds_read_b128 a[36:39], v11 offset:0
    ds_read_b128 v[100:103], v19 offset:0
    v_mfma_f32_32x32x16_bf16 v[40:55], a[28:31], v[104:107], v[40:55]
    ds_read_b128 v[104:107], v19 offset:4096
    v_mfma_f32_32x32x16_bf16 v[56:71], v[108:111], a[28:31], v[56:71]
    ds_read_b64_tr_b16 v[108:109], v17 offset:2048
    ds_read_b64_tr_b16 v[110:111], v17 offset:2560
    s_waitcnt lgkmcnt(5)
    v_mfma_f32_32x32x16_bf16 v[24:39], a[32:35], v[88:91], v[24:39]
    ds_read_b128 a[40:43], v12 offset:0
    ds_read_b128 v[88:91], v20 offset:0
    v_mfma_f32_32x32x16_bf16 v[40:55], a[32:35], v[92:95], v[40:55]
    ds_read_b128 v[92:95], v20 offset:4096
    v_mfma_f32_32x32x16_bf16 v[56:71], v[96:99], a[32:35], v[56:71]
    ds_read_b64_tr_b16 v[96:97], v17 offset:4096
    ds_read_b64_tr_b16 v[98:99], v17 offset:4608
    s_waitcnt lgkmcnt(5)
    v_mfma_f32_32x32x16_bf16 v[24:39], a[36:39], v[100:103], v[24:39]
    ds_read_b128 a[44:47], v13 offset:0
    ds_read_b128 v[100:103], v21 offset:0
    v_mfma_f32_32x32x16_bf16 v[40:55], a[36:39], v[104:107], v[40:55]
    ds_read_b128 v[104:107], v21 offset:4096
    v_mfma_f32_32x32x16_bf16 v[56:71], v[108:111], a[36:39], v[56:71]
    ds_read_b64_tr_b16 v[108:109], v17 offset:6144
    ds_read_b64_tr_b16 v[110:111], v17 offset:6656
    s_waitcnt vmcnt(5)
    s_barrier
    s_waitcnt lgkmcnt(5)
    v_mfma_f32_32x32x16_bf16 v[24:39], a[40:43], v[88:91], v[24:39]
    ds_read_b128 a[48:51], v10 offset:40960
    ds_read_b128 v[88:91], v18 offset:40960
    s_add_u32 s85, s4, 5
    s_and_b32 s85, s85, 7
    s_lshl_b32 s87, s85, 7
    s_mul_i32 s85, s85, 229376
    s_add_u32 m0, s96, 40960
    s_add_u32 s93, s87, 0
    buffer_load_dwordx4 v4, s[44:47], s93 offen lds
    s_add_u32 m0, s97, 65536
    s_add_u32 s93, s85, 0
    buffer_load_dwordx4 v7, s[52:55], s93 offen lds
    s_add_u32 m0, s96, 41984
    s_add_u32 s93, s87, 0
    buffer_load_dwordx4 v5, s[44:47], s93 offen lds
    s_add_u32 m0, s97, 73728
    s_add_u32 s93, s85, 0
    buffer_load_dwordx4 v8, s[56:59], s93 offen lds
    v_mfma_f32_32x32x16_bf16 v[40:55], a[40:43], v[92:95], v[40:55]
    ds_read_b128 v[92:95], v18 offset:45056
    s_add_u32 m0, s97, 57344
    s_add_u32 s93, s87, 0
    buffer_load_dwordx4 v6, s[48:51], s93 offen lds
    v_lshlrev_b32 v126, 16, v126
    v_lshlrev_b32 v127, 16, v127
    v_mfma_f32_32x32x16_bf16 v[56:71], v[96:99], a[40:43], v[56:71]
    ds_read_b64_tr_b16 v[96:97], v17 offset:40960
    ds_read_b64_tr_b16 v[98:99], v17 offset:41472
    v_lshlrev_b32 v86, 16, v86
    v_mul_f32 v86, 0x3fb8aa3b, v86
    v_exp_f32 v86, v86
    s_nop 0
    s_waitcnt lgkmcnt(5)
    v_mfma_f32_32x32x16_bf16 v[24:39], a[44:47], v[100:103], v[24:39]
    ds_read_b128 a[52:55], v11 offset:40960
    ds_read_b128 v[100:103], v19 offset:40960
    v_cvt_pk_bf16_f32 v86, v86, v86
    v_lshlrev_b32 v86, 16, v86
    v_mul_f32 v116, v86, v126
    v_mul_f32 v117, v86, v127
    v_mfma_f32_32x32x16_bf16 v[40:55], a[44:47], v[104:107], v[40:55]
    ds_read_b128 v[104:107], v19 offset:45056
    v_mul_f32 v116, 0x3fb8aa3b, v116
    v_mul_f32 v117, 0.15915494, v117
    v_exp_f32 v116, v116
    v_rndne_f32 v118, v117
    v_mfma_f32_32x32x16_bf16 v[56:71], v[108:111], a[44:47], v[56:71]
    ds_read_b64_tr_b16 v[108:109], v17 offset:43008
    ds_read_b64_tr_b16 v[110:111], v17 offset:43520
    v_sub_f32 v117, v117, v118
    v_cos_f32 v120, v117
    v_sin_f32 v121, v117
    v_mul_f32 v118, v126, v126
    s_waitcnt lgkmcnt(5)
    v_mfma_f32_32x32x16_bf16 v[24:39], a[48:51], v[88:91], v[24:39]
    ds_read_b128 a[56:59], v12 offset:40960
    ds_read_b128 v[88:91], v20 offset:40960
    v_mul_f32 v120, v120, v116
    v_mul_f32 v121, v121, v116
    v_fmac_f32 v118, v127, v127
    v_add_f32 v116, -1.0, v120
    v_mfma_f32_32x32x16_bf16 v[40:55], a[48:51], v[92:95], v[40:55]
    ds_read_b128 v[92:95], v20 offset:45056
    v_rcp_f32 v118, v118
    v_mul_f32 v124, v116, v126
    v_mul_f32 v125, v121, v126
    v_fmac_f32 v124, v121, v127
    v_mfma_f32_32x32x16_bf16 v[56:71], v[96:99], a[48:51], v[56:71]
    ds_read_b64_tr_b16 v[96:97], v17 offset:45056
    ds_read_b64_tr_b16 v[98:99], v17 offset:45568
    v_fma_f32 v125, -v116, v127, v125
    v_add_f32 v118, v118, v118
    v_mul_f32 v124, v124, v118
    v_mul_f32 v125, v125, v118
    s_waitcnt lgkmcnt(5)
    v_mfma_f32_32x32x16_bf16 v[24:39], a[52:55], v[100:103], v[24:39]
    ds_read_b128 a[60:63], v13 offset:40960
    ds_read_b128 v[100:103], v21 offset:40960
    v_mul_f32 v116, v121, v121
    v_mul_f32 v117, v120, v121
    v_fma_f32 v116, v120, v120, -v116
    v_fma_f32 v123, v121, v120, v117
    v_mfma_f32_32x32x16_bf16 v[40:55], a[52:55], v[104:107], v[40:55]
    ds_read_b128 v[104:107], v21 offset:45056
    v_mov_b32 v122, v116
    v_mul_f32 v116, v123, v123
    v_mul_f32 v117, v122, v123
    v_fma_f32 v116, v122, v122, -v116
    v_mfma_f32_32x32x16_bf16 v[56:71], v[108:111], a[52:55], v[56:71]
    ds_read_b64_tr_b16 v[108:109], v17 offset:47104
    ds_read_b64_tr_b16 v[110:111], v17 offset:47616
    v_fma_f32 v123, v123, v122, v117
    v_mov_b32 v122, v116
    v_mul_f32 v116, v123, v123
    v_mul_f32 v117, v122, v123
    s_waitcnt vmcnt(5)
    s_barrier
    s_waitcnt lgkmcnt(5)
    v_mfma_f32_32x32x16_bf16 v[24:39], a[56:59], v[88:91], v[24:39]
    v_subrev_u32 v10, 81920, v10
    v_subrev_u32 v11, 81920, v11
    v_subrev_u32 v12, 81920, v12
    v_subrev_u32 v13, 81920, v13
    v_subrev_u32 v18, 81920, v18
    v_subrev_u32 v19, 81920, v19
    v_subrev_u32 v20, 81920, v20
    v_subrev_u32 v21, 81920, v21
    v_subrev_u32 v17, 81920, v17
    ds_read_b128 a[64:67], v10 offset:0
    ds_read_b128 v[88:91], v18 offset:0
    s_add_u32 s85, s4, 6
    s_and_b32 s85, s85, 7
    s_lshl_b32 s87, s85, 7
    s_mul_i32 s85, s85, 229376
    s_add_u32 m0, s96, 81920
    s_add_u32 s93, s87, 0
    buffer_load_dwordx4 v4, s[44:47], s93 offen lds
    s_add_u32 m0, s97, 106496
    s_add_u32 s93, s85, 0
    buffer_load_dwordx4 v7, s[52:55], s93 offen lds
    s_add_u32 m0, s96, 82944
    s_add_u32 s93, s87, 0
    buffer_load_dwordx4 v5, s[44:47], s93 offen lds
    s_add_u32 m0, s97, 114688
    s_add_u32 s93, s85, 0
    buffer_load_dwordx4 v8, s[56:59], s93 offen lds
    v_mfma_f32_32x32x16_bf16 v[40:55], a[56:59], v[92:95], v[40:55]
    ds_read_b128 v[92:95], v18 offset:4096
    s_add_u32 m0, s97, 98304
    s_add_u32 s93, s87, 0
    buffer_load_dwordx4 v6, s[48:51], s93 offen lds
    v_fma_f32 v116, v122, v122, -v116
    v_fma_f32 v123, v123, v122, v117
    v_mov_b32 v122, v116
    v_mfma_f32_32x32x16_bf16 v[56:71], v[96:99], a[56:59], v[56:71]
    ds_read_b64_tr_b16 v[96:97], v17 offset:0
    ds_read_b64_tr_b16 v[98:99], v17 offset:512
    v_mul_f32 v116, v123, v123
    v_mul_f32 v117, v122, v123
    v_fma_f32 v116, v122, v122, -v116
    v_fma_f32 v123, v123, v122, v117
    s_waitcnt lgkmcnt(5)
    v_mfma_f32_32x32x16_bf16 v[24:39], a[60:63], v[100:103], v[24:39]
    ds_read_b128 a[68:71], v11 offset:0
    ds_read_b128 v[100:103], v19 offset:0
    v_mov_b32 v122, v116
    v_cmp_lt_u32 vcc, 31, v1
    v_mov_b32 v3, 0
    v_mov_b32 v2, 1.0
    v_mfma_f32_32x32x16_bf16 v[40:55], a[60:63], v[104:107], v[40:55]
    ds_read_b128 v[104:107], v19 offset:4096
    v_cndmask_b32 v3, v3, v123, vcc
    v_cndmask_b32 v2, v2, v122, vcc
    v_mul_f32 v116, v123, v123
    v_mul_f32 v117, v122, v123
    v_mfma_f32_32x32x16_bf16 v[56:71], v[108:111], a[60:63], v[56:71]
    ds_read_b64_tr_b16 v[108:109], v17 offset:2048
    ds_read_b64_tr_b16 v[110:111], v17 offset:2560
    v_fma_f32 v116, v122, v122, -v116
    v_fma_f32 v15, v123, v122, v117
    v_mov_b32 v9, v116
    v_mul_f32 v116, v3, v15
    s_waitcnt lgkmcnt(5)
    v_mfma_f32_32x32x16_bf16 v[24:39], a[64:67], v[88:91], v[24:39]
    ds_read_b128 a[72:75], v12 offset:0
    ds_read_b128 v[88:91], v20 offset:0
    v_mul_f32 v117, v2, v15
    v_fma_f32 v116, v2, v9, -v116
    v_fma_f32 v113, v3, v9, v117
    v_mov_b32 v112, v116
    v_mfma_f32_32x32x16_bf16 v[40:55], a[64:67], v[92:95], v[40:55]
    ds_read_b128 v[92:95], v20 offset:4096
    s_bitcmp1_b32 s42, 0
    s_cselect_b64 vcc, -1, 0
    s_nop 1
    v_cndmask_b32 v2, v2, v112, vcc
    v_cndmask_b32 v3, v3, v113, vcc
    v_mfma_f32_32x32x16_bf16 v[56:71], v[96:99], a[64:67], v[56:71]
    ds_read_b64_tr_b16 v[96:97], v17 offset:4096
    ds_read_b64_tr_b16 v[98:99], v17 offset:4608
    v_mul_f32 v116, v15, v15
    v_mul_f32 v117, v9, v15
    v_fma_f32 v116, v9, v9, -v116
    v_fma_f32 v15, v15, v9, v117
    s_waitcnt lgkmcnt(5)
    v_mfma_f32_32x32x16_bf16 v[24:39], a[68:71], v[100:103], v[24:39]
    ds_read_b128 a[76:79], v13 offset:0
    ds_read_b128 v[100:103], v21 offset:0
    v_mov_b32 v9, v116
    v_mul_f32 v116, v3, v15
    v_mul_f32 v117, v2, v15
    v_fma_f32 v116, v2, v9, -v116
    v_mfma_f32_32x32x16_bf16 v[40:55], a[68:71], v[104:107], v[40:55]
    ds_read_b128 v[104:107], v21 offset:4096
    v_fma_f32 v113, v3, v9, v117
    v_mov_b32 v112, v116
    s_bitcmp1_b32 s42, 1
    s_cselect_b64 vcc, -1, 0
    s_nop 1
    v_mfma_f32_32x32x16_bf16 v[56:71], v[108:111], a[68:71], v[56:71]
    ds_read_b64_tr_b16 v[108:109], v17 offset:6144
    ds_read_b64_tr_b16 v[110:111], v17 offset:6656
    v_cndmask_b32 v2, v2, v112, vcc
    v_cndmask_b32 v3, v3, v113, vcc
    v_mul_f32 v116, v15, v15
    v_mul_f32 v117, v9, v15
    s_waitcnt vmcnt(5)
    s_barrier
    s_waitcnt lgkmcnt(5)
    v_mfma_f32_32x32x16_bf16 v[24:39], a[72:75], v[88:91], v[24:39]
    ds_read_b128 a[80:83], v10 offset:40960
    ds_read_b128 v[88:91], v18 offset:40960
    s_add_u32 s85, s4, 7
    s_and_b32 s85, s85, 7
    s_lshl_b32 s87, s85, 7
    s_mul_i32 s85, s85, 229376
    s_add_u32 m0, s96, 122880
    s_add_u32 s93, s87, 0
    buffer_load_dwordx4 v4, s[44:47], s93 offen lds
    s_add_u32 m0, s97, 147456
    s_add_u32 s93, s85, 0
    buffer_load_dwordx4 v7, s[52:55], s93 offen lds
    s_add_u32 m0, s96, 123904
    s_add_u32 s93, s87, 0
    buffer_load_dwordx4 v5, s[44:47], s93 offen lds
    s_add_u32 m0, s97, 155648
    s_add_u32 s93, s85, 0
    buffer_load_dwordx4 v8, s[56:59], s93 offen lds
    v_mfma_f32_32x32x16_bf16 v[40:55], a[72:75], v[92:95], v[40:55]
    ds_read_b128 v[92:95], v18 offset:45056
    s_add_u32 m0, s97, 139264
    s_add_u32 s93, s87, 0
    buffer_load_dwordx4 v6, s[48:51], s93 offen lds
    buffer_load_dwordx2 v[114:115], off, s[72:75], 0 sc1
    v_fma_f32 v116, v9, v9, -v116
    v_fma_f32 v15, v15, v9, v117
    v_mfma_f32_32x32x16_bf16 v[56:71], v[96:99], a[72:75], v[56:71]
    ds_read_b64_tr_b16 v[96:97], v17 offset:40960
    ds_read_b64_tr_b16 v[98:99], v17 offset:41472
    v_mov_b32 v9, v116
    v_mov_b32 v84, 0
    v_mov_b32 v85, 0
    s_waitcnt lgkmcnt(5)
    v_mfma_f32_32x32x16_bf16 v[24:39], a[76:79], v[100:103], v[24:39]
    ds_read_b128 a[84:87], v11 offset:40960
    ds_read_b128 v[100:103], v19 offset:40960
    v_lshlrev_b32 v116, 16, v80
    v_and_b32 v117, 0xffff0000, v80
    v_lshlrev_b32 v118, 16, v72
    v_and_b32 v119, 0xffff0000, v72
    v_mfma_f32_32x32x16_bf16 v[40:55], a[76:79], v[104:107], v[40:55]
    ds_read_b128 v[104:107], v19 offset:45056
    v_mul_f32 v118, v118, v116
    v_mul_f32 v119, v119, v117
    v_cvt_pk_bf16_f32 v118, v118, v119
    v_and_b32 v119, 0xffff0000, v118
    v_mfma_f32_32x32x16_bf16 v[56:71], v[108:111], a[76:79], v[56:71]
    ds_read_b64_tr_b16 v[108:109], v17 offset:43008
    ds_read_b64_tr_b16 v[110:111], v17 offset:43520
    v_lshlrev_b32 v118, 16, v118
    v_add_f32 v84, v84, v119
    v_add_f32 v84, v84, v118
    v_lshlrev_b32 v118, 16, v76
    s_waitcnt lgkmcnt(5)
    v_mfma_f32_32x32x16_bf16 v[24:39], a[80:83], v[88:91], v[24:39]
    ds_read_b128 a[88:91], v12 offset:40960
    ds_read_b128 v[88:91], v20 offset:40960
    v_and_b32 v119, 0xffff0000, v76
    v_mul_f32 v118, v118, v116
    v_mul_f32 v119, v119, v117
    v_cvt_pk_bf16_f32 v118, v118, v119
    v_mfma_f32_32x32x16_bf16 v[40:55], a[80:83], v[92:95], v[40:55]
    ds_read_b128 v[92:95], v20 offset:45056
    v_and_b32 v119, 0xffff0000, v118
    v_lshlrev_b32 v118, 16, v118
    v_add_f32 v85, v85, v119
    v_add_f32 v85, v85, v118
    v_mfma_f32_32x32x16_bf16 v[56:71], v[96:99], a[80:83], v[56:71]
    ds_read_b64_tr_b16 v[96:97], v17 offset:45056
    ds_read_b64_tr_b16 v[98:99], v17 offset:45568
    v_lshlrev_b32 v116, 16, v81
    v_and_b32 v117, 0xffff0000, v81
    v_lshlrev_b32 v118, 16, v73
    v_and_b32 v119, 0xffff0000, v73
    s_waitcnt lgkmcnt(5)
    v_mfma_f32_32x32x16_bf16 v[24:39], a[84:87], v[100:103], v[24:39]
    ds_read_b128 a[92:95], v13 offset:40960
    ds_read_b128 v[100:103], v21 offset:40960
    v_mul_f32 v118, v118, v116
    v_mul_f32 v119, v119, v117
    v_cvt_pk_bf16_f32 v118, v118, v119
    v_and_b32 v119, 0xffff0000, v118
    v_mfma_f32_32x32x16_bf16 v[40:55], a[84:87], v[104:107], v[40:55]
    ds_read_b128 v[104:107], v21 offset:45056
    v_lshlrev_b32 v118, 16, v118
    v_add_f32 v84, v84, v119
    v_add_f32 v84, v84, v118
    v_lshlrev_b32 v118, 16, v77
    v_mfma_f32_32x32x16_bf16 v[56:71], v[108:111], a[84:87], v[56:71]
    ds_read_b64_tr_b16 v[108:109], v17 offset:47104
    ds_read_b64_tr_b16 v[110:111], v17 offset:47616
    v_and_b32 v119, 0xffff0000, v77
    v_mul_f32 v118, v118, v116
    v_mul_f32 v119, v119, v117
    v_cvt_pk_bf16_f32 v118, v118, v119
    s_waitcnt vmcnt(6)
    s_barrier
    s_waitcnt lgkmcnt(5)
    v_mfma_f32_32x32x16_bf16 v[24:39], a[88:91], v[88:91], v[24:39]
    v_add_u32 v10, 81920, v10
    v_add_u32 v11, 81920, v11
    v_add_u32 v12, 81920, v12
    v_add_u32 v13, 81920, v13
    v_add_u32 v18, 81920, v18
    v_add_u32 v19, 81920, v19
    v_add_u32 v20, 81920, v20
    v_add_u32 v21, 81920, v21
    v_add_u32 v17, 81920, v17
    ds_read_b128 a[96:99], v10 offset:0
    ds_read_b128 v[88:91], v18 offset:0
    s_mul_i32 s86, s6, 96
    s_add_u32 s86, s86, 2048
    s_and_b32 s99, s42, 1
    s_mul_i32 s99, s99, 114688
    s_add_u32 s86, s86, s99
    v_add_u32 v86, 0, v1
    v_mul_u32_u24 v23, 43691, v86
    v_lshrrev_b32 v23, 18, v23
    v_mfma_f32_32x32x16_bf16 v[40:55], a[88:91], v[92:95], v[40:55]
    ds_read_b128 v[92:95], v18 offset:4096
    v_mul_u32_u24 v87, 6, v23
    v_sub_u32 v87, v86, v87
    v_mul_u32_u24 v23, 3584, v23
    v_lshl_add_u32 v23, v87, 4, v23
    v_mfma_f32_32x32x16_bf16 v[56:71], v[96:99], a[88:91], v[56:71]
    ds_read_b64_tr_b16 v[96:97], v17 offset:0
    ds_read_b64_tr_b16 v[98:99], v17 offset:512
    v_add_u32 v4, s86, v23
    v_add_u32 v86, 64, v1
    v_mul_u32_u24 v23, 43691, v86
    v_lshrrev_b32 v23, 18, v23
    s_waitcnt lgkmcnt(5)
    v_mfma_f32_32x32x16_bf16 v[24:39], a[92:95], v[100:103], v[24:39]
    ds_read_b128 a[100:103], v11 offset:0
    ds_read_b128 v[100:103], v19 offset:0
    v_mul_u32_u24 v87, 6, v23
    v_sub_u32 v87, v86, v87
    v_mul_u32_u24 v23, 3584, v23
    v_lshl_add_u32 v23, v87, 4, v23
    v_mfma_f32_32x32x16_bf16 v[40:55], a[92:95], v[104:107], v[40:55]
    ds_read_b128 v[104:107], v19 offset:4096
    v_add_u32 v5, s86, v23
    v_add_u32 v86, 128, v1
    v_mul_u32_u24 v23, 43691, v86
    v_lshrrev_b32 v23, 18, v23
    v_mfma_f32_32x32x16_bf16 v[56:71], v[108:111], a[92:95], v[56:71]
    ds_read_b64_tr_b16 v[108:109], v17 offset:2048
    ds_read_b64_tr_b16 v[110:111], v17 offset:2560
    v_mul_u32_u24 v87, 6, v23
    v_sub_u32 v87, v86, v87
    v_mul_u32_u24 v23, 3584, v23
    v_lshl_add_u32 v23, v87, 4, v23
    s_waitcnt lgkmcnt(5)
    v_mfma_f32_32x32x16_bf16 v[24:39], a[96:99], v[88:91], v[24:39]
    ds_read_b128 a[104:107], v12 offset:0
    ds_read_b128 v[88:91], v20 offset:0
    v_add_u32 v6, s86, v23
    s_lshr_b32 s85, s42, 1
    s_add_u32 s85, s85, s4
    s_add_u32 s85, s85, 0
    s_and_b32 s85, s85, 7
    s_mul_i32 s85, s85, 229376
    s_add_u32 m0, s98, 0
    s_add_u32 s93, s85, 0
    buffer_load_dwordx4 v4, s[52:55], s93 offen lds
    s_add_u32 m0, s98, 12416
    s_add_u32 s93, s85, 0
    buffer_load_dwordx4 v4, s[56:59], s93 offen lds
    s_add_u32 m0, s98, 1024
    s_add_u32 s93, s85, 0
    buffer_load_dwordx4 v5, s[52:55], s93 offen lds
    v_mfma_f32_32x32x16_bf16 v[40:55], a[96:99], v[92:95], v[40:55]
    ds_read_b128 v[92:95], v20 offset:4096
    s_add_u32 m0, s98, 13440
    s_add_u32 s93, s85, 0
    buffer_load_dwordx4 v5, s[56:59], s93 offen lds
    s_add_u32 m0, s98, 2048
    s_add_u32 s93, s85, 0
    buffer_load_dwordx4 v6, s[52:55], s93 offen lds
    s_add_u32 m0, s98, 14464
    s_add_u32 s93, s85, 0
    buffer_load_dwordx4 v6, s[56:59], s93 offen lds
    v_and_b32 v119, 0xffff0000, v118
    v_mfma_f32_32x32x16_bf16 v[56:71], v[96:99], a[96:99], v[56:71]
    ds_read_b64_tr_b16 v[96:97], v17 offset:4096
    ds_read_b64_tr_b16 v[98:99], v17 offset:4608
    v_lshlrev_b32 v118, 16, v118
    v_add_f32 v85, v85, v119
    v_add_f32 v85, v85, v118
    v_lshlrev_b32 v116, 16, v82
    s_waitcnt lgkmcnt(5)
    v_mfma_f32_32x32x16_bf16 v[24:39], a[100:103], v[100:103], v[24:39]
    ds_read_b128 a[108:111], v13 offset:0
    ds_read_b128 v[100:103], v21 offset:0
    v_and_b32 v117, 0xffff0000, v82
    v_lshlrev_b32 v118, 16, v74
    v_and_b32 v119, 0xffff0000, v74
    v_mul_f32 v118, v118, v116
    v_mfma_f32_32x32x16_bf16 v[40:55], a[100:103], v[104:107], v[40:55]
    ds_read_b128 v[104:107], v21 offset:4096
    v_mul_f32 v119, v119, v117
    v_cvt_pk_bf16_f32 v118, v118, v119
    v_and_b32 v119, 0xffff0000, v118
    v_lshlrev_b32 v118, 16, v118
    v_mfma_f32_32x32x16_bf16 v[56:71], v[108:111], a[100:103], v[56:71]
    ds_read_b64_tr_b16 v[108:109], v17 offset:6144
    ds_read_b64_tr_b16 v[110:111], v17 offset:6656
    v_add_f32 v84, v84, v119
    v_add_f32 v84, v84, v118
    v_lshlrev_b32 v118, 16, v78
    v_and_b32 v119, 0xffff0000, v78
    s_waitcnt vmcnt(7)
    s_barrier
    s_waitcnt lgkmcnt(5)
    v_mfma_f32_32x32x16_bf16 v[24:39], a[104:107], v[88:91], v[24:39]
    ds_read_b128 a[112:115], v10 offset:40960
    ds_read_b128 v[88:91], v18 offset:40960
    s_lshr_b32 s85, s42, 1
    s_add_u32 s85, s85, s4
    s_add_u32 s85, s85, 2
    s_and_b32 s85, s85, 7
    s_mul_i32 s85, s85, 229376
    s_add_u32 m0, s98, 40960
    s_add_u32 s93, s85, 0
    buffer_load_dwordx4 v4, s[52:55], s93 offen lds
    s_add_u32 m0, s98, 53376
    s_add_u32 s93, s85, 0
    buffer_load_dwordx4 v4, s[56:59], s93 offen lds
    s_add_u32 m0, s98, 41984
    s_add_u32 s93, s85, 0
    buffer_load_dwordx4 v5, s[52:55], s93 offen lds
    s_add_u32 m0, s98, 54400
    s_add_u32 s93, s85, 0
    buffer_load_dwordx4 v5, s[56:59], s93 offen lds
    v_mfma_f32_32x32x16_bf16 v[40:55], a[104:107], v[92:95], v[40:55]
    ds_read_b128 v[92:95], v18 offset:45056
    s_add_u32 m0, s98, 43008
    s_add_u32 s93, s85, 0
    buffer_load_dwordx4 v6, s[52:55], s93 offen lds
    s_add_u32 m0, s98, 55424
    s_add_u32 s93, s85, 0
    buffer_load_dwordx4 v6, s[56:59], s93 offen lds
    v_mul_f32 v118, v118, v116
    v_mul_f32 v119, v119, v117
    v_mfma_f32_32x32x16_bf16 v[56:71], v[96:99], a[104:107], v[56:71]
    ds_read_b64_tr_b16 v[96:97], v17 offset:40960
    ds_read_b64_tr_b16 v[98:99], v17 offset:41472
    v_cvt_pk_bf16_f32 v118, v118, v119
    v_and_b32 v119, 0xffff0000, v118
    v_lshlrev_b32 v118, 16, v118
    v_add_f32 v85, v85, v119
    s_waitcnt lgkmcnt(5)
    v_mfma_f32_32x32x16_bf16 v[24:39], a[108:111], v[100:103], v[24:39]
    ds_read_b128 a[116:119], v11 offset:40960
    ds_read_b128 v[100:103], v19 offset:40960
    v_add_f32 v85, v85, v118
    v_lshlrev_b32 v116, 16, v83
    v_and_b32 v117, 0xffff0000, v83
    v_lshlrev_b32 v118, 16, v75
    v_mfma_f32_32x32x16_bf16 v[40:55], a[108:111], v[104:107], v[40:55]
    ds_read_b128 v[104:107], v19 offset:45056
    v_and_b32 v119, 0xffff0000, v75
    v_mul_f32 v118, v118, v116
    v_mul_f32 v119, v119, v117
    v_cvt_pk_bf16_f32 v118, v118, v119
    v_mfma_f32_32x32x16_bf16 v[56:71], v[108:111], a[108:111], v[56:71]
    ds_read_b64_tr_b16 v[108:109], v17 offset:43008
    ds_read_b64_tr_b16 v[110:111], v17 offset:43520
    v_and_b32 v119, 0xffff0000, v118
    v_lshlrev_b32 v118, 16, v118
    v_add_f32 v84, v84, v119
    v_add_f32 v84, v84, v118
    s_waitcnt lgkmcnt(5)
    v_mfma_f32_32x32x16_bf16 v[24:39], a[112:115], v[88:91], v[24:39]
    ds_read_b128 a[120:123], v12 offset:40960
    ds_read_b128 v[88:91], v20 offset:40960
    v_lshlrev_b32 v118, 16, v79
    v_and_b32 v119, 0xffff0000, v79
    v_mul_f32 v118, v118, v116
    v_mul_f32 v119, v119, v117
    v_mfma_f32_32x32x16_bf16 v[40:55], a[112:115], v[92:95], v[40:55]
    ds_read_b128 v[92:95], v20 offset:45056
    v_cvt_pk_bf16_f32 v118, v118, v119
    v_and_b32 v119, 0xffff0000, v118
    v_lshlrev_b32 v118, 16, v118
    v_add_f32 v85, v85, v119
    v_mfma_f32_32x32x16_bf16 v[56:71], v[96:99], a[112:115], v[56:71]
    ds_read_b64_tr_b16 v[96:97], v17 offset:45056
    ds_read_b64_tr_b16 v[98:99], v17 offset:45568
    v_add_f32 v85, v85, v118
    s_nop 1
    v_add_f32_dpp v84, v84, v84 row_shr:1 row_mask:0xf bank_mask:0xf
    v_add_f32_dpp v85, v85, v85 row_shr:1 row_mask:0xf bank_mask:0xf
    s_waitcnt lgkmcnt(5)
    v_mfma_f32_32x32x16_bf16 v[24:39], a[116:119], v[100:103], v[24:39]
    ds_read_b128 a[124:127], v13 offset:40960
    ds_read_b128 v[100:103], v21 offset:40960
    s_nop 1
    v_add_f32_dpp v84, v84, v84 row_shr:2 row_mask:0xf bank_mask:0xf
    v_add_f32_dpp v85, v85, v85 row_shr:2 row_mask:0xf bank_mask:0xf
    s_nop 1
    v_mfma_f32_32x32x16_bf16 v[40:55], a[116:119], v[104:107], v[40:55]
    ds_read_b128 v[104:107], v21 offset:45056
    v_add_f32_dpp v84, v84, v84 row_shr:4 row_mask:0xf bank_mask:0xf
    v_add_f32_dpp v85, v85, v85 row_shr:4 row_mask:0xf bank_mask:0xf
    s_nop 1
    v_add_f32_dpp v84, v84, v84 row_shr:8 row_mask:0xf bank_mask:0xf
    v_mfma_f32_32x32x16_bf16 v[56:71], v[108:111], a[116:119], v[56:71]
    ds_read_b64_tr_b16 v[108:109], v17 offset:47104
    ds_read_b64_tr_b16 v[110:111], v17 offset:47616
    v_add_f32_dpp v85, v85, v85 row_shr:8 row_mask:0xf bank_mask:0xf
    s_nop 1
    v_add_f32_dpp v84, v84, v84 row_bcast:15 row_mask:0xa bank_mask:0xf
    v_add_f32_dpp v85, v85, v85 row_bcast:15 row_mask:0xa bank_mask:0xf
    s_nop 1
    v_add_f32_dpp v84, v84, v84 row_bcast:31 row_mask:0xc bank_mask:0xf
    v_add_f32_dpp v85, v85, v85 row_bcast:31 row_mask:0xc bank_mask:0xf
    s_nop 1
    v_readlane_b32 s99, v84, 63
    v_readlane_b32 s100, v85, 63
    s_nop 1
    v_mov_b32 v118, s99
    v_writelane_b32 v118, s100, 1
    s_nop 0
    v_cvt_pk_bf16_f32 v118, v118, v118
    v_lshlrev_b32 v118, 16, v118
    v_mul_f32 v118, s92, v118
    v_exp_f32 v118, v118
    v_lshlrev_b32 v116, 3, v1
    v_add_f32 v118, 1.0, v118
    v_cmp_gt_u32 vcc, 2, v1
    v_rcp_f32 v118, v118
    v_mov_b32 v117, 0x7ffffff0
    v_cvt_pk_bf16_f32 v118, v118, v118
    v_cndmask_b32 v116, v117, v116, vcc
    v_lshlrev_b32 v118, 16, v118
    v_sub_f32 v119, 1.0, v118
    v_cvt_pk_bf16_f32 v119, v119, v119
    v_lshlrev_b32 v119, 16, v119
    s_lshl_b32 s99, s11, 3
    s_add_u32 s99, s99, 0x1000000
    buffer_store_dwordx2 v[118:119], v116, s[64:67], s99 offen sc1
    s_waitcnt vmcnt(7)
    s_barrier
    s_waitcnt lgkmcnt(5)
    v_mfma_f32_32x32x16_bf16 v[24:39], a[120:123], v[88:91], v[24:39]
    s_lshr_b32 s85, s42, 1
    s_add_u32 s85, s85, s4
    s_add_u32 s85, s85, 4
    s_and_b32 s85, s85, 7
    s_mul_i32 s85, s85, 229376
    s_add_u32 m0, s98, 81920
    s_add_u32 s93, s85, 0
    buffer_load_dwordx4 v4, s[52:55], s93 offen lds
    s_add_u32 m0, s98, 94336
    s_add_u32 s93, s85, 0
    buffer_load_dwordx4 v4, s[56:59], s93 offen lds
    s_add_u32 m0, s98, 82944
    s_add_u32 s93, s85, 0
    buffer_load_dwordx4 v5, s[52:55], s93 offen lds
    s_add_u32 m0, s98, 95360
    s_add_u32 s93, s85, 0
    buffer_load_dwordx4 v5, s[56:59], s93 offen lds
    v_mfma_f32_32x32x16_bf16 v[40:55], a[120:123], v[92:95], v[40:55]
    s_add_u32 m0, s98, 83968
    s_add_u32 s93, s85, 0
    buffer_load_dwordx4 v6, s[52:55], s93 offen lds
    s_add_u32 m0, s98, 96384
    s_add_u32 s93, s85, 0
    buffer_load_dwordx4 v6, s[56:59], s93 offen lds
    v_mfma_f32_32x32x16_bf16 v[56:71], v[96:99], a[120:123], v[56:71]
    ds_read_b64_tr_b16 v[88:89], v16 offset:0
    ds_read_b64_tr_b16 v[90:91], v16 offset:384
    s_waitcnt lgkmcnt(2)
    v_mfma_f32_32x32x16_bf16 v[24:39], a[124:127], v[100:103], v[24:39]
    v_mfma_f32_32x32x16_bf16 v[40:55], a[124:127], v[104:107], v[40:55]
    v_mfma_f32_32x32x16_bf16 v[56:71], v[108:111], a[124:127], v[56:71]
    ds_read_b64_tr_b16 v[100:101], v16 offset:1536
    ds_read_b64_tr_b16 v[102:103], v16 offset:1920
    s_waitcnt lgkmcnt(2)
    v_mfma_f32_32x32x16_bf16 v[72:87], v[88:91], a[0:3], 0
    ds_read_b64_tr_b16 v[88:89], v16 offset:3072
    ds_read_b64_tr_b16 v[90:91], v16 offset:3456
    s_waitcnt lgkmcnt(2)
    v_mfma_f32_32x32x16_bf16 v[72:87], v[100:103], a[4:7], v[72:87]
    ds_read_b64_tr_b16 v[100:101], v16 offset:4608
    ds_read_b64_tr_b16 v[102:103], v16 offset:4992
    v_mov_b32 v118, 0
    v_mov_b32 v119, 0
    ds_write_b64 v22, v[118:119]
    v_mov_b32 v23, 162048
    ds_write_b64 v23, v[118:119]
    s_nop 7
    v_fma_f32 v112, v120, v24, v25
    v_fma_f32 v113, v120, v40, v41
    v_fma_f32 v112, -v121, v40, v112
    v_fma_f32 v113, v121, v24, v113
    v_fma_f32 v116, v120, v112, v26
    v_fma_f32 v117, v120, v113, v42
    v_fma_f32 v116, -v121, v113, v116
    v_fma_f32 v117, v121, v112, v117
    s_waitcnt lgkmcnt(4)
    v_mfma_f32_32x32x16_bf16 v[72:87], v[88:91], a[8:11], v[72:87]
    ds_read_b64_tr_b16 v[88:89], v16 offset:6144
    ds_read_b64_tr_b16 v[90:91], v16 offset:6528
    v_fma_f32 v112, v120, v116, v27
    v_fma_f32 v113, v120, v117, v43
    v_fma_f32 v112, -v121, v117, v112
    v_fma_f32 v113, v121, v116, v113
    v_fma_f32 v116, v120, v112, v28
    v_fma_f32 v117, v120, v113, v44
    v_fma_f32 v116, -v121, v113, v116
    v_fma_f32 v117, v121, v112, v117
    v_fma_f32 v112, v120, v116, v29
    v_fma_f32 v113, v120, v117, v45
    v_fma_f32 v112, -v121, v117, v112
    v_fma_f32 v113, v121, v116, v113
    v_fma_f32 v116, v120, v112, v30
    v_fma_f32 v117, v120, v113, v46
    s_waitcnt lgkmcnt(4)
    v_mfma_f32_32x32x16_bf16 v[72:87], v[100:103], a[12:15], v[72:87]
    ds_read_b64_tr_b16 v[100:101], v16 offset:7680
    ds_read_b64_tr_b16 v[102:103], v16 offset:8064
    v_fma_f32 v116, -v121, v113, v116
    v_fma_f32 v117, v121, v112, v117
    v_fma_f32 v112, v120, v116, v31
    v_fma_f32 v113, v120, v117, v47
    v_fma_f32 v112, -v121, v117, v112
    v_fma_f32 v113, v121, v116, v113
    v_fma_f32 v116, v120, v112, v32
    v_fma_f32 v117, v120, v113, v48
    v_fma_f32 v116, -v121, v113, v116
    v_fma_f32 v117, v121, v112, v117
    v_fma_f32 v112, v120, v116, v33
    v_fma_f32 v113, v120, v117, v49
    v_fma_f32 v112, -v121, v117, v112
    v_fma_f32 v113, v121, v116, v113
    s_waitcnt lgkmcnt(2)
    v_mfma_f32_32x32x16_bf16 v[72:87], v[88:91], a[16:19], v[72:87]
    ds_read_b64_tr_b16 v[88:89], v16 offset:9216
    ds_read_b64_tr_b16 v[90:91], v16 offset:9600
    v_fma_f32 v116, v120, v112, v34
    v_fma_f32 v117, v120, v113, v50
    v_fma_f32 v116, -v121, v113, v116
    v_fma_f32 v117, v121, v112, v117
    v_fma_f32 v112, v120, v116, v35
    v_fma_f32 v113, v120, v117, v51
    v_fma_f32 v112, -v121, v117, v112
    v_fma_f32 v113, v121, v116, v113
    v_fma_f32 v116, v120, v112, v36
    v_fma_f32 v117, v120, v113, v52
    v_fma_f32 v116, -v121, v113, v116
    v_fma_f32 v117, v121, v112, v117
    v_fma_f32 v112, v120, v116, v37
    v_fma_f32 v113, v120, v117, v53
    s_waitcnt lgkmcnt(2)
    v_mfma_f32_32x32x16_bf16 v[72:87], v[100:103], a[20:23], v[72:87]
    ds_read_b64_tr_b16 v[100:101], v16 offset:10752
    ds_read_b64_tr_b16 v[102:103], v16 offset:11136
    v_fma_f32 v112, -v121, v117, v112
    v_fma_f32 v113, v121, v116, v113
    v_fma_f32 v116, v120, v112, v38
    v_fma_f32 v117, v120, v113, v54
    v_fma_f32 v116, -v121, v113, v116
    v_fma_f32 v117, v121, v112, v117
    v_fma_f32 v112, v120, v116, v39
    v_fma_f32 v113, v120, v117, v55
    v_fma_f32 v112, -v121, v117, v112
    v_fma_f32 v113, v121, v116, v113
    ds_write_b64 v22, v[112:113] offset:2048
    s_lshl_b32 s99, s6, 13
    s_add_u32 s99, s99, 0x1100000
    s_add_u32 s68, s40, s99
    s_addc_u32 s69, s41, 0
    s_mov_b32 s70, 8192
    s_mov_b32 s71, 0x00020000
    s_waitcnt lgkmcnt(0)
    s_waitcnt vmcnt(7)
    s_barrier
    ds_read_b64 v[108:109], v22 offset:256
    ds_read_b64 v[106:107], v22 offset:512
    ds_read_b64 v[104:105], v22 offset:768
    ds_read_b64 v[98:99], v22 offset:1024
    ds_read_b64 v[96:97], v22 offset:1280
    ds_read_b64 v[94:95], v22 offset:1536
    ds_read_b64 v[92:93], v22 offset:1792
    v_lshlrev_b32 v118, 4, v1
    s_lshl_b32 s99, s5, 9
    s_sub_u32 s99, s99, 512
    v_add_u32 v118, s99, v118
    s_mov_b32 s93, 0x40000
K1_TAGCHK1:
    v_readfirstlane_b32 s12, v114
    v_readfirstlane_b32 s13, v115
    s_sub_u32 s93, s93, 1
    s_cmp_eq_u32 s93, 0
    s_cbranch_scc1 K1_TAGOK2
    s_cmp_lg_u32 s12, 0
    s_cbranch_scc1 K1_TAGOK2
    s_sleep 1
    buffer_load_dwordx2 v[114:115], off, s[72:75], 0 sc1
    s_waitcnt vmcnt(0)
    s_branch K1_TAGCHK1
K1_TAGOK2:
    s_waitcnt lgkmcnt(5)
    v_fma_f32 v116, v122, v108, v106
    v_fma_f32 v117, v122, v109, v107
    v_fma_f32 v116, -v123, v109, v116
    v_fma_f32 v117, v123, v108, v117
    s_waitcnt lgkmcnt(4)
    v_fma_f32 v126, v122, v116, v104
    v_fma_f32 v127, v122, v117, v105
    v_fma_f32 v126, -v123, v117, v126
    v_fma_f32 v127, v123, v116, v127
    s_waitcnt lgkmcnt(3)
    v_fma_f32 v116, v122, v126, v98
    v_fma_f32 v117, v122, v127, v99
    v_fma_f32 v116, -v123, v127, v116
    v_fma_f32 v117, v123, v126, v117
    s_waitcnt lgkmcnt(2)
    v_fma_f32 v126, v122, v116, v96
    v_fma_f32 v127, v122, v117, v97
    v_fma_f32 v126, -v123, v117, v126
    v_fma_f32 v127, v123, v116, v127
    s_waitcnt lgkmcnt(1)
    v_fma_f32 v116, v122, v126, v94
    v_fma_f32 v117, v122, v127, v95
    v_fma_f32 v116, -v123, v127, v116
    v_fma_f32 v117, v123, v126, v117
    s_waitcnt lgkmcnt(0)
    v_fma_f32 v126, v122, v116, v92
    v_fma_f32 v127, v122, v117, v93
    v_fma_f32 v126, -v123, v117, v126
    v_fma_f32 v127, v123, v116, v127
    s_cmp_eq_u32 s42, 3
    s_cbranch_scc0 K1_NOPUB
    s_cmp_eq_u32 s5, 15
    s_cbranch_scc1 K1_NOPUB
    v_fma_f32 v112, v122, v126, v112
    v_fma_f32 v113, v122, v127, v113
    v_fma_f32 v112, -v123, v127, v112
    v_fma_f32 v113, v123, v126, v113
    s_mov_b32 exec_lo, 0
    buffer_store_dwordx4 v[112:115], v118, s[68:71], 0 offen sc1
    s_mov_b32 exec_lo, -1
K1_NOPUB:
    v_mfma_f32_32x32x16_bf16 v[72:87], v[88:91], a[24:27], v[72:87]
    ds_read_b64_tr_b16 v[88:89], v16 offset:40960
    ds_read_b64_tr_b16 v[90:91], v16 offset:41344
    s_lshr_b32 s85, s42, 1
    s_add_u32 s85, s85, s4
    s_add_u32 s85, s85, 6
    s_and_b32 s85, s85, 7
    s_mul_i32 s85, s85, 229376
    s_add_u32 m0, s98, 122880
    s_add_u32 s93, s85, 0
    buffer_load_dwordx4 v4, s[52:55], s93 offen lds
    s_add_u32 m0, s98, 135296
    s_add_u32 s93, s85, 0
    buffer_load_dwordx4 v4, s[56:59], s93 offen lds
    s_add_u32 m0, s98, 123904
    s_add_u32 s93, s85, 0
    buffer_load_dwordx4 v5, s[52:55], s93 offen lds
    s_add_u32 m0, s98, 136320
    s_add_u32 s93, s85, 0
    buffer_load_dwordx4 v5, s[56:59], s93 offen lds
    s_add_u32 m0, s98, 124928
    s_add_u32 s93, s85, 0
    buffer_load_dwordx4 v6, s[52:55], s93 offen lds
    s_add_u32 m0, s98, 137344
    s_add_u32 s93, s85, 0
    buffer_load_dwordx4 v6, s[56:59], s93 offen lds
    v_pk_mul_f32 v[56:57], v[56:57], s[92:93] op_sel_hi:[1,0]
    v_pk_mul_f32 v[58:59], v[58:59], s[92:93] op_sel_hi:[1,0]
    v_pk_mul_f32 v[60:61], v[60:61], s[92:93] op_sel_hi:[1,0]
    v_pk_mul_f32 v[62:63], v[62:63], s[92:93] op_sel_hi:[1,0]
    v_exp_f32 v56, v56
    v_exp_f32 v57, v57
    v_exp_f32 v58, v58
    v_exp_f32 v59, v59
    v_mfma_f32_32x32x16_bf16 v[72:87], v[100:103], a[28:31], v[72:87]
    ds_read_b64_tr_b16 v[100:101], v16 offset:42496
    ds_read_b64_tr_b16 v[102:103], v16 offset:42880
    v_exp_f32 v60, v60
    v_exp_f32 v61, v61
    v_exp_f32 v62, v62
    v_exp_f32 v63, v63
    v_pk_add_f32 v[56:57], v[56:57], 1.0 op_sel_hi:[1,0]
    v_pk_add_f32 v[58:59], v[58:59], 1.0 op_sel_hi:[1,0]
    v_pk_add_f32 v[60:61], v[60:61], 1.0 op_sel_hi:[1,0]
    v_pk_add_f32 v[62:63], v[62:63], 1.0 op_sel_hi:[1,0]
    v_rcp_f32 v56, v56
    v_rcp_f32 v57, v57
    v_rcp_f32 v58, v58
    v_rcp_f32 v59, v59
    v_rcp_f32 v60, v60
    v_rcp_f32 v61, v61
    s_mul_i32 s100, s26, 360448
    s_add_u32 s52, s40, s100
    s_addc_u32 s53, s41, 0
    s_mov_b32 s54, 0x58000
    s_mov_b32 s56, s36
    s_mov_b32 s57, s37
    s_mov_b32 s58, 0x400000
    s_mov_b32 s59, 0x00020000
    s_mov_b32 s48, s18
    s_mov_b32 s49, s19
    s_mov_b32 s50, 0x80000
    s_mov_b32 s51, 0x00020000
    s_mov_b32 s88, s20
    s_mov_b32 s89, s21
    s_mov_b32 s90, 0x80000
    s_mov_b32 s91, 0x00020000
    v_lshrrev_b32 v20, 3, v1
    v_lshlrev_b32 v22, 10, v20
    v_lshrrev_b32 v20, 1, v20
    v_xor_b32 v20, v20, v1
    v_and_b32 v20, 7, v20
    v_lshl_add_u32 v22, v20, 4, v22
    v_xor_b32 v23, 64, v22
    v_add_u32 v23, 7168, v23
    s_lshl_b32 s4, s27, 16
    s_lshl_b32 s99, s42, 8
    s_add_u32 s4, s4, s99
    s_lshl_b32 s22, s42, 15
    s_lshr_b32 s99, s42, 1
    s_mul_i32 s23, s99, 40960
    s_and_b32 s99, s42, 1
    s_mul_i32 s99, s99, 12288
    s_add_u32 s23, s23, s99
    s_waitcnt lgkmcnt(2)
    v_mfma_f32_32x32x16_bf16 v[72:87], v[88:91], a[32:35], v[72:87]
    ds_read_b64_tr_b16 v[88:89], v16 offset:44032
    ds_read_b64_tr_b16 v[90:91], v16 offset:44416
    v_rcp_f32 v62, v62
    v_rcp_f32 v63, v63
    v_pk_mul_f32 v[56:57], v[56:57], v[64:65]
    v_pk_mul_f32 v[58:59], v[58:59], v[66:67]
    v_pk_mul_f32 v[60:61], v[60:61], v[68:69]
    v_pk_mul_f32 v[62:63], v[62:63], v[70:71]
    v_cvt_pk_bf16_f32 v64, v56, v57
    v_cvt_pk_bf16_f32 v65, v58, v59
    v_cvt_pk_bf16_f32 v66, v60, v61
    v_cvt_pk_bf16_f32 v67, v62, v63
    s_add_u32 s93, s84, 0
    buffer_store_dwordx4 v[64:67], v14, s[64:67], s93 offen sc1
    v_mul_f32 v116, v15, v15
    v_mul_f32 v117, v9, v15
    v_fma_f32 v116, v9, v9, -v116
    s_waitcnt lgkmcnt(2)
    v_mfma_f32_32x32x16_bf16 v[72:87], v[100:103], a[36:39], v[72:87]
    ds_read_b64_tr_b16 v[100:101], v16 offset:45568
    ds_read_b64_tr_b16 v[102:103], v16 offset:45952
    v_fma_f32 v105, v15, v9, v117
    v_mov_b32 v104, v116
    s_waitcnt lgkmcnt(2)
    v_mfma_f32_32x32x16_bf16 v[72:87], v[88:91], a[40:43], v[72:87]
    ds_read_b64_tr_b16 v[88:89], v16 offset:47104
    ds_read_b64_tr_b16 v[90:91], v16 offset:47488
    s_waitcnt lgkmcnt(2)
    v_mfma_f32_32x32x16_bf16 v[72:87], v[100:103], a[44:47], v[72:87]
    ds_read_b64_tr_b16 v[100:101], v16 offset:48640
    ds_read_b64_tr_b16 v[102:103], v16 offset:49024
    s_waitcnt lgkmcnt(2)
    v_mfma_f32_32x32x16_bf16 v[72:87], v[88:91], a[48:51], v[72:87]
    ds_read_b64_tr_b16 v[88:89], v16 offset:50176
    ds_read_b64_tr_b16 v[90:91], v16 offset:50560
    s_waitcnt lgkmcnt(2)
    v_mfma_f32_32x32x16_bf16 v[72:87], v[100:103], a[52:55], v[72:87]
    ds_read_b64_tr_b16 v[100:101], v16 offset:51712
    ds_read_b64_tr_b16 v[102:103], v16 offset:52096
    s_waitcnt vmcnt(7)
    s_barrier
    s_waitcnt lgkmcnt(2)
    v_mfma_f32_32x32x16_bf16 v[72:87], v[88:91], a[56:59], v[72:87]
    v_add_u32 v16, 81920, v16
    ds_read_b64_tr_b16 v[88:89], v16 offset:0
    ds_read_b64_tr_b16 v[90:91], v16 offset:384
    v_lshrrev_b32 v20, 5, v1
    v_and_b32 v18, 31, v1
    v_lshlrev_b32 v18, 4, v18
    v_sub_u32 v19, s5, v20
    v_lshl_add_u32 v18, v19, 9, v18
    v_subrev_u32 v18, 512, v18
    v_mov_b32 v20, v18
    buffer_load_dwordx4 a[0:3], v20, s[68:71], 0 offen sc1
    v_subrev_u32 v20, 1024, v20
    buffer_load_dwordx4 a[4:7], v20, s[68:71], 0 offen sc1
    v_subrev_u32 v20, 1024, v20
    buffer_load_dwordx4 a[8:11], v20, s[68:71], 0 offen sc1
    v_subrev_u32 v20, 1024, v20
    buffer_load_dwordx4 a[12:15], v20, s[68:71], 0 offen sc1
    v_subrev_u32 v20, 1024, v20
    buffer_load_dwordx4 a[16:19], v20, s[68:71], 0 offen sc1
    v_subrev_u32 v20, 1024, v20
    buffer_load_dwordx4 a[20:23], v20, s[68:71], 0 offen sc1
    v_subrev_u32 v20, 1024, v20
    buffer_load_dwordx4 a[24:27], v20, s[68:71], 0 offen sc1
    v_subrev_u32 v20, 1024, v20
    buffer_load_dwordx4 a[28:31], v20, s[68:71], 0 offen sc1
    s_waitcnt lgkmcnt(2)
    v_mfma_f32_32x32x16_bf16 v[72:87], v[100:103], a[60:63], v[72:87]
    ds_read_b64_tr_b16 v[100:101], v16 offset:1536
    ds_read_b64_tr_b16 v[102:103], v16 offset:1920
    s_waitcnt lgkmcnt(2)
    v_mfma_f32_32x32x16_bf16 v[72:87], v[88:91], a[64:67], v[72:87]
    ds_read_b64_tr_b16 v[88:89], v16 offset:3072
    ds_read_b64_tr_b16 v[90:91], v16 offset:3456
    s_waitcnt lgkmcnt(2)
    v_mfma_f32_32x32x16_bf16 v[72:87], v[100:103], a[68:71], v[72:87]
    ds_read_b64_tr_b16 v[100:101], v16 offset:4608
    ds_read_b64_tr_b16 v[102:103], v16 offset:4992
    s_waitcnt lgkmcnt(2)
    v_mfma_f32_32x32x16_bf16 v[72:87], v[88:91], a[72:75], v[72:87]
    ds_read_b64_tr_b16 v[88:89], v16 offset:6144
    ds_read_b64_tr_b16 v[90:91], v16 offset:6528
    s_waitcnt lgkmcnt(2)
    v_mfma_f32_32x32x16_bf16 v[72:87], v[100:103], a[76:79], v[72:87]
    ds_read_b64_tr_b16 v[100:101], v16 offset:7680
    ds_read_b64_tr_b16 v[102:103], v16 offset:8064
    s_waitcnt lgkmcnt(2)
    v_mfma_f32_32x32x16_bf16 v[72:87], v[88:91], a[80:83], v[72:87]
    ds_read_b64_tr_b16 v[88:89], v16 offset:9216
    ds_read_b64_tr_b16 v[90:91], v16 offset:9600
    s_waitcnt lgkmcnt(2)
    v_mfma_f32_32x32x16_bf16 v[72:87], v[100:103], a[84:87], v[72:87]
    ds_read_b64_tr_b16 v[100:101], v16 offset:10752
    ds_read_b64_tr_b16 v[102:103], v16 offset:11136
    s_waitcnt vmcnt(8)
    s_barrier
    v_mov_b32 v112, 0
    v_mov_b32 v113, 0
    s_cmp_eq_u32 s5, 0
    s_cbranch_scc1 K1_NOG
    s_mov_b32 s93, 0x40000
    s_waitcnt vmcnt(0)
K1_CHECK:
    s_mov_b64 s[0:1], 0
    v_accvgpr_read_b32 v116, a2
    v_accvgpr_read_b32 v117, a3
    v_accvgpr_read_b32 v56, a0
    v_accvgpr_read_b32 v57, a1
    v_cmp_ne_u64 s[76:77], v[116:117], v[114:115]
    v_cmp_lt_i32 vcc, 0, v19
    s_and_b64 s[76:77], s[76:77], vcc
    s_or_b64 s[0:1], s[0:1], s[76:77]
    v_accvgpr_read_b32 v116, a6
    v_accvgpr_read_b32 v117, a7
    v_accvgpr_read_b32 v58, a4
    v_accvgpr_read_b32 v59, a5
    v_cmp_ne_u64 s[76:77], v[116:117], v[114:115]
    v_cmp_lt_i32 vcc, 2, v19
    s_and_b64 s[76:77], s[76:77], vcc
    s_or_b64 s[0:1], s[0:1], s[76:77]
    v_accvgpr_read_b32 v116, a10
    v_accvgpr_read_b32 v117, a11
    v_accvgpr_read_b32 v60, a8
    v_accvgpr_read_b32 v61, a9
    v_cmp_ne_u64 s[76:77], v[116:117], v[114:115]
    v_cmp_lt_i32 vcc, 4, v19
    s_and_b64 s[76:77], s[76:77], vcc
    s_or_b64 s[0:1], s[0:1], s[76:77]
    v_accvgpr_read_b32 v116, a14
    v_accvgpr_read_b32 v117, a15
    v_accvgpr_read_b32 v62, a12
    v_accvgpr_read_b32 v63, a13
    v_cmp_ne_u64 s[76:77], v[116:117], v[114:115]
    v_cmp_lt_i32 vcc, 6, v19
    s_and_b64 s[76:77], s[76:77], vcc
    s_or_b64 s[0:1], s[0:1], s[76:77]
    v_accvgpr_read_b32 v116, a18
    v_accvgpr_read_b32 v117, a19
    v_accvgpr_read_b32 v64, a16
    v_accvgpr_read_b32 v65, a17
    v_cmp_ne_u64 s[76:77], v[116:117], v[114:115]
    v_cmp_lt_i32 vcc, 8, v19
    s_and_b64 s[76:77], s[76:77], vcc
    s_or_b64 s[0:1], s[0:1], s[76:77]
    v_accvgpr_read_b32 v116, a22
    v_accvgpr_read_b32 v117, a23
    v_accvgpr_read_b32 v66, a20
    v_accvgpr_read_b32 v67, a21
    v_cmp_ne_u64 s[76:77], v[116:117], v[114:115]
    v_cmp_lt_i32 vcc, 10, v19
    s_and_b64 s[76:77], s[76:77], vcc
    s_or_b64 s[0:1], s[0:1], s[76:77]
    v_accvgpr_read_b32 v116, a26
    v_accvgpr_read_b32 v117, a27
    v_accvgpr_read_b32 v68, a24
    v_accvgpr_read_b32 v69, a25
    v_cmp_ne_u64 s[76:77], v[116:117], v[114:115]
    v_cmp_lt_i32 vcc, 12, v19
    s_and_b64 s[76:77], s[76:77], vcc
    s_or_b64 s[0:1], s[0:1], s[76:77]
    v_accvgpr_read_b32 v116, a30
    v_accvgpr_read_b32 v117, a31
    v_accvgpr_read_b32 v70, a28
    v_accvgpr_read_b32 v71, a29
    v_cmp_ne_u64 s[76:77], v[116:117], v[114:115]
    v_cmp_lt_i32 vcc, 14, v19
    s_and_b64 s[76:77], s[76:77], vcc
    s_or_b64 s[0:1], s[0:1], s[76:77]
    s_cmp_eq_u64 s[0:1], 0
    s_cbranch_scc1 K1_GOT
    s_sub_u32 s93, s93, 1
    s_cmp_eq_u32 s93, 0
    s_cbranch_scc1 K1_GOT
    s_sleep 1
    v_mov_b32 v20, v18
    buffer_load_dwordx4 a[0:3], v20, s[68:71], 0 offen sc1
    v_subrev_u32 v20, 1024, v20
    buffer_load_dwordx4 a[4:7], v20, s[68:71], 0 offen sc1
    v_subrev_u32 v20, 1024, v20
    buffer_load_dwordx4 a[8:11], v20, s[68:71], 0 offen sc1
    v_subrev_u32 v20, 1024, v20
    buffer_load_dwordx4 a[12:15], v20, s[68:71], 0 offen sc1
    v_subrev_u32 v20, 1024, v20
    buffer_load_dwordx4 a[16:19], v20, s[68:71], 0 offen sc1
    v_subrev_u32 v20, 1024, v20
    buffer_load_dwordx4 a[20:23], v20, s[68:71], 0 offen sc1
    v_subrev_u32 v20, 1024, v20
    buffer_load_dwordx4 a[24:27], v20, s[68:71], 0 offen sc1
    v_subrev_u32 v20, 1024, v20
    buffer_load_dwordx4 a[28:31], v20, s[68:71], 0 offen sc1
    s_waitcnt vmcnt(0)
    s_branch K1_CHECK
K1_GOT:
    v_fma_f32 v112, v104, v70, v68
    v_fma_f32 v113, v104, v71, v69
    v_fma_f32 v112, -v105, v71, v112
    v_fma_f32 v113, v105, v70, v113
    v_fma_f32 v116, v104, v112, v66
    v_fma_f32 v117, v104, v113, v67
    v_fma_f32 v116, -v105, v113, v116
    v_fma_f32 v117, v105, v112, v117
    v_fma_f32 v112, v104, v116, v64
    v_fma_f32 v113, v104, v117, v65
    v_fma_f32 v112, -v105, v117, v112
    v_fma_f32 v113, v105, v116, v113
    v_fma_f32 v116, v104, v112, v62
    v_fma_f32 v117, v104, v113, v63
    v_fma_f32 v116, -v105, v113, v116
    v_fma_f32 v117, v105, v112, v117
    v_fma_f32 v112, v104, v116, v60
    v_fma_f32 v113, v104, v117, v61
    v_fma_f32 v112, -v105, v117, v112
    v_fma_f32 v113, v105, v116, v113
    v_fma_f32 v116, v104, v112, v58
    v_fma_f32 v117, v104, v113, v59
    v_fma_f32 v116, -v105, v113, v116
    v_fma_f32 v117, v105, v112, v117
    v_fma_f32 v112, v104, v116, v56
    v_fma_f32 v113, v104, v117, v57
    v_fma_f32 v112, -v105, v117, v112
    v_fma_f32 v113, v105, v116, v113
    v_mov_b32 v116, v112
    v_mov_b32 v117, v113
    s_nop 1
    v_permlane32_swap_b32 v112, v116
    v_permlane32_swap_b32 v113, v117
    s_nop 0
    v_fma_f32 v112, v9, v116, v112
    v_fma_f32 v113, v9, v117, v113
    v_fma_f32 v112, -v15, v117, v112
    v_fma_f32 v113, v15, v116, v113
K1_NOG:
    v_fma_f32 v126, v2, v112, v126
    v_fma_f32 v127, v2, v113, v127
    v_fma_f32 v126, -v3, v113, v126
    v_fma_f32 v127, v3, v112, v127
    s_waitcnt lgkmcnt(2)
    v_mfma_f32_32x32x16_bf16 v[72:87], v[88:91], a[88:91], v[72:87]
    ds_read_b64_tr_b16 v[88:89], v16 offset:40960
    ds_read_b64_tr_b16 v[90:91], v16 offset:41344
    v_fma_f32 v24, v120, v126, v24
    v_fma_f32 v40, v120, v127, v40
    v_fma_f32 v24, -v121, v127, v24
    v_fma_f32 v40, v121, v126, v40
    v_fma_f32 v25, v120, v24, v25
    v_fma_f32 v41, v120, v40, v41
    v_fma_f32 v25, -v121, v40, v25
    v_fma_f32 v41, v121, v24, v41
    v_fma_f32 v26, v120, v25, v26
    v_fma_f32 v42, v120, v41, v42
    v_fma_f32 v26, -v121, v41, v26
    v_fma_f32 v42, v121, v25, v42
    v_pk_mul_f32 v[116:117], v[124:125], v[40:41] op_sel:[1,0] op_sel_hi:[1,1]
    v_pk_mul_f32 v[118:119], v[124:125], v[24:25] op_sel:[1,0] op_sel_hi:[1,1]
    s_waitcnt lgkmcnt(2)
    v_mfma_f32_32x32x16_bf16 v[72:87], v[100:103], a[92:95], v[72:87]
    ds_read_b64_tr_b16 v[100:101], v16 offset:42496
    ds_read_b64_tr_b16 v[102:103], v16 offset:42880
    v_pk_fma_f32 v[24:25], v[124:125], v[24:25], v[116:117] op_sel_hi:[0,1,1] neg_lo:[0,0,1] neg_hi:[0,0,1]
    v_pk_fma_f32 v[40:41], v[124:125], v[40:41], v[118:119] op_sel_hi:[0,1,1] neg_lo:[1,0,1] neg_hi:[1,0,1]
    v_fma_f32 v27, v120, v26, v27
    v_fma_f32 v43, v120, v42, v43
    v_fma_f32 v27, -v121, v42, v27
    v_fma_f32 v43, v121, v26, v43
    v_fma_f32 v28, v120, v27, v28
    v_fma_f32 v44, v120, v43, v44
    v_fma_f32 v28, -v121, v43, v28
    v_fma_f32 v44, v121, v27, v44
    v_pk_mul_f32 v[116:117], v[124:125], v[42:43] op_sel:[1,0] op_sel_hi:[1,1]
    v_pk_mul_f32 v[118:119], v[124:125], v[26:27] op_sel:[1,0] op_sel_hi:[1,1]
    v_pk_fma_f32 v[26:27], v[124:125], v[26:27], v[116:117] op_sel_hi:[0,1,1] neg_lo:[0,0,1] neg_hi:[0,0,1]
    v_pk_fma_f32 v[42:43], v[124:125], v[42:43], v[118:119] op_sel_hi:[0,1,1] neg_lo:[1,0,1] neg_hi:[1,0,1]
    s_waitcnt lgkmcnt(2)
    v_mfma_f32_32x32x16_bf16 v[72:87], v[88:91], a[96:99], v[72:87]
    ds_read_b64_tr_b16 v[88:89], v16 offset:44032
    ds_read_b64_tr_b16 v[90:91], v16 offset:44416
    v_fma_f32 v29, v120, v28, v29
    v_fma_f32 v45, v120, v44, v45
    v_fma_f32 v29, -v121, v44, v29
    v_fma_f32 v45, v121, v28, v45
    v_fma_f32 v30, v120, v29, v30
    v_fma_f32 v46, v120, v45, v46
    v_fma_f32 v30, -v121, v45, v30
    v_fma_f32 v46, v121, v29, v46
    v_pk_mul_f32 v[116:117], v[124:125], v[44:45] op_sel:[1,0] op_sel_hi:[1,1]
    v_pk_mul_f32 v[118:119], v[124:125], v[28:29] op_sel:[1,0] op_sel_hi:[1,1]
    v_pk_fma_f32 v[28:29], v[124:125], v[28:29], v[116:117] op_sel_hi:[0,1,1] neg_lo:[0,0,1] neg_hi:[0,0,1]
    v_pk_fma_f32 v[44:45], v[124:125], v[44:45], v[118:119] op_sel_hi:[0,1,1] neg_lo:[1,0,1] neg_hi:[1,0,1]
    v_fma_f32 v31, v120, v30, v31
    v_fma_f32 v47, v120, v46, v47
    s_waitcnt lgkmcnt(2)
    v_mfma_f32_32x32x16_bf16 v[72:87], v[100:103], a[100:103], v[72:87]
    ds_read_b64_tr_b16 v[100:101], v16 offset:45568
    ds_read_b64_tr_b16 v[102:103], v16 offset:45952
    v_fma_f32 v31, -v121, v46, v31
    v_fma_f32 v47, v121, v30, v47
    v_fma_f32 v32, v120, v31, v32
    v_fma_f32 v48, v120, v47, v48
    v_fma_f32 v32, -v121, v47, v32
    v_fma_f32 v48, v121, v31, v48
    v_pk_mul_f32 v[116:117], v[124:125], v[46:47] op_sel:[1,0] op_sel_hi:[1,1]
    v_pk_mul_f32 v[118:119], v[124:125], v[30:31] op_sel:[1,0] op_sel_hi:[1,1]
    v_pk_fma_f32 v[30:31], v[124:125], v[30:31], v[116:117] op_sel_hi:[0,1,1] neg_lo:[0,0,1] neg_hi:[0,0,1]
    v_pk_fma_f32 v[46:47], v[124:125], v[46:47], v[118:119] op_sel_hi:[0,1,1] neg_lo:[1,0,1] neg_hi:[1,0,1]
    v_fma_f32 v33, v120, v32, v33
    v_fma_f32 v49, v120, v48, v49
    v_fma_f32 v33, -v121, v48, v33
    v_fma_f32 v49, v121, v32, v49
    s_waitcnt lgkmcnt(2)
    v_mfma_f32_32x32x16_bf16 v[72:87], v[88:91], a[104:107], v[72:87]
    ds_read_b64_tr_b16 v[88:89], v16 offset:47104
    ds_read_b64_tr_b16 v[90:91], v16 offset:47488
    v_fma_f32 v34, v120, v33, v34
    v_fma_f32 v50, v120, v49, v50
    v_fma_f32 v34, -v121, v49, v34
    v_fma_f32 v50, v121, v33, v50
    v_pk_mul_f32 v[116:117], v[124:125], v[48:49] op_sel:[1,0] op_sel_hi:[1,1]
    v_pk_mul_f32 v[118:119], v[124:125], v[32:33] op_sel:[1,0] op_sel_hi:[1,1]
    v_pk_fma_f32 v[32:33], v[124:125], v[32:33], v[116:117] op_sel_hi:[0,1,1] neg_lo:[0,0,1] neg_hi:[0,0,1]
    v_pk_fma_f32 v[48:49], v[124:125], v[48:49], v[118:119] op_sel_hi:[0,1,1] neg_lo:[1,0,1] neg_hi:[1,0,1]
    v_fma_f32 v35, v120, v34, v35
    v_fma_f32 v51, v120, v50, v51
    v_fma_f32 v35, -v121, v50, v35
    v_fma_f32 v51, v121, v34, v51
    v_fma_f32 v36, v120, v35, v36
    v_fma_f32 v52, v120, v51, v52
    s_waitcnt lgkmcnt(2)
    v_mfma_f32_32x32x16_bf16 v[72:87], v[100:103], a[108:111], v[72:87]
    ds_read_b64_tr_b16 v[100:101], v16 offset:48640
    ds_read_b64_tr_b16 v[102:103], v16 offset:49024
    v_fma_f32 v36, -v121, v51, v36
    v_fma_f32 v52, v121, v35, v52
    v_pk_mul_f32 v[116:117], v[124:125], v[50:51] op_sel:[1,0] op_sel_hi:[1,1]
    v_pk_mul_f32 v[118:119], v[124:125], v[34:35] op_sel:[1,0] op_sel_hi:[1,1]
    v_pk_fma_f32 v[34:35], v[124:125], v[34:35], v[116:117] op_sel_hi:[0,1,1] neg_lo:[0,0,1] neg_hi:[0,0,1]
    v_pk_fma_f32 v[50:51], v[124:125], v[50:51], v[118:119] op_sel_hi:[0,1,1] neg_lo:[1,0,1] neg_hi:[1,0,1]
    v_fma_f32 v37, v120, v36, v37
    v_fma_f32 v53, v120, v52, v53
    v_fma_f32 v37, -v121, v52, v37
    v_fma_f32 v53, v121, v36, v53
    v_fma_f32 v38, v120, v37, v38
    v_fma_f32 v54, v120, v53, v54
    v_fma_f32 v38, -v121, v53, v38
    v_fma_f32 v54, v121, v37, v54
    s_waitcnt lgkmcnt(2)
    v_mfma_f32_32x32x16_bf16 v[72:87], v[88:91], a[112:115], v[72:87]
    ds_read_b64_tr_b16 v[88:89], v16 offset:50176
    ds_read_b64_tr_b16 v[90:91], v16 offset:50560
    v_pk_mul_f32 v[116:117], v[124:125], v[52:53] op_sel:[1,0] op_sel_hi:[1,1]
    v_pk_mul_f32 v[118:119], v[124:125], v[36:37] op_sel:[1,0] op_sel_hi:[1,1]
    v_pk_fma_f32 v[36:37], v[124:125], v[36:37], v[116:117] op_sel_hi:[0,1,1] neg_lo:[0,0,1] neg_hi:[0,0,1]
    v_pk_fma_f32 v[52:53], v[124:125], v[52:53], v[118:119] op_sel_hi:[0,1,1] neg_lo:[1,0,1] neg_hi:[1,0,1]
    v_fma_f32 v39, v120, v38, v39
    v_fma_f32 v55, v120, v54, v55
    v_fma_f32 v39, -v121, v54, v39
    v_fma_f32 v55, v121, v38, v55
    v_pk_mul_f32 v[116:117], v[124:125], v[54:55] op_sel:[1,0] op_sel_hi:[1,1]
    v_pk_mul_f32 v[118:119], v[124:125], v[38:39] op_sel:[1,0] op_sel_hi:[1,1]
    v_pk_fma_f32 v[38:39], v[124:125], v[38:39], v[116:117] op_sel_hi:[0,1,1] neg_lo:[0,0,1] neg_hi:[0,0,1]
    v_pk_fma_f32 v[54:55], v[124:125], v[54:55], v[118:119] op_sel_hi:[0,1,1] neg_lo:[1,0,1] neg_hi:[1,0,1]
    v_cvt_pk_bf16_f32 v24, v24, v25
    v_cvt_pk_bf16_f32 v25, v26, v27
    s_waitcnt lgkmcnt(2)
    v_mfma_f32_32x32x16_bf16 v[72:87], v[100:103], a[116:119], v[72:87]
    ds_read_b64_tr_b16 v[100:101], v16 offset:51712
    ds_read_b64_tr_b16 v[102:103], v16 offset:52096
    v_cvt_pk_bf16_f32 v26, v28, v29
    v_cvt_pk_bf16_f32 v27, v30, v31
    v_cvt_pk_bf16_f32 v28, v32, v33
    v_cvt_pk_bf16_f32 v29, v34, v35
    v_cvt_pk_bf16_f32 v30, v36, v37
    v_cvt_pk_bf16_f32 v31, v38, v39
    v_cvt_pk_bf16_f32 v40, v40, v41
    v_cvt_pk_bf16_f32 v41, v42, v43
    v_cvt_pk_bf16_f32 v42, v44, v45
    v_cvt_pk_bf16_f32 v43, v46, v47
    v_cvt_pk_bf16_f32 v44, v48, v49
    v_cvt_pk_bf16_f32 v45, v50, v51
    v_cvt_pk_bf16_f32 v46, v52, v53
    v_cvt_pk_bf16_f32 v47, v54, v55
    s_waitcnt lgkmcnt(2)
    v_mfma_f32_32x32x16_bf16 v[72:87], v[88:91], a[120:123], v[72:87]
    s_mul_i32 s86, s42, 40960
    s_add_u32 s86, s86, 35072
    v_and_b32 v116, 31, v1
    v_lshlrev_b32 v116, 6, v116
    v_lshrrev_b32 v117, 5, v1
    v_lshl_add_u32 v116, v117, 5, v116
    v_add_u32 v116, s86, v116
    ds_write_b128 v116, v[24:27] offset:0
    ds_write_b128 v116, v[28:31] offset:16
    ds_write_b128 v116, v[40:43] offset:2048
    ds_write_b128 v116, v[44:47] offset:2064
    v_bfe_u32 v118, v1, 2, 2
    v_lshl_add_u32 v118, v117, 3, v118
    v_lshlrev_b32 v118, 6, v118
    s_waitcnt lgkmcnt(4)
    v_mfma_f32_32x32x16_bf16 v[72:87], v[100:103], a[124:127], v[72:87]
    v_and_b32 v119, 1, v1
    v_lshl_add_u32 v118, v119, 5, v118
    v_bfe_u32 v119, v1, 1, 1
    v_lshl_add_u32 v118, v119, 3, v118
    v_bfe_u32 v119, v1, 4, 1
    v_lshl_add_u32 v118, v119, 4, v118
    v_add_u32 v118, s86, v118
    s_waitcnt lgkmcnt(0)
    ds_read_b64_tr_b16 v[56:57], v118 offset:0
    ds_read_b64_tr_b16 v[58:59], v118 offset:256
    ds_read_b64_tr_b16 v[60:61], v118 offset:1024
    ds_read_b64_tr_b16 v[62:63], v118 offset:1280
    ds_read_b64_tr_b16 v[64:65], v118 offset:2048
    ds_read_b64_tr_b16 v[66:67], v118 offset:2304
    ds_read_b64_tr_b16 v[68:69], v118 offset:3072
    ds_read_b64_tr_b16 v[70:71], v118 offset:3328
    s_waitcnt lgkmcnt(6)
    s_add_u32 s93, s94, 0
    buffer_store_dwordx4 v[56:59], v14, s[64:67], s93 offen sc1
    s_waitcnt lgkmcnt(4)
    s_add_u32 s93, s94, 2048
    buffer_store_dwordx4 v[60:63], v14, s[64:67], s93 offen sc1
    s_waitcnt lgkmcnt(2)
    s_add_u32 s93, s94, 4096
    buffer_store_dwordx4 v[64:67], v14, s[64:67], s93 offen sc1
    s_waitcnt lgkmcnt(0)
    s_add_u32 s93, s94, 6144
    buffer_store_dwordx4 v[68:71], v14, s[64:67], s93 offen sc1
    s_nop 7
    s_nop 3
    v_pk_mul_f32 v[72:73], v[72:73], s[92:93] op_sel_hi:[1,0]
    v_pk_mul_f32 v[74:75], v[74:75], s[92:93] op_sel_hi:[1,0]
    v_pk_mul_f32 v[76:77], v[76:77], s[92:93] op_sel_hi:[1,0]
    v_pk_mul_f32 v[78:79], v[78:79], s[92:93] op_sel_hi:[1,0]
    v_exp_f32 v72, v72
    v_exp_f32 v73, v73
    v_exp_f32 v74, v74
    v_exp_f32 v75, v75
    v_exp_f32 v76, v76
    v_exp_f32 v77, v77
    v_exp_f32 v78, v78
    v_exp_f32 v79, v79
    v_pk_add_f32 v[72:73], v[72:73], 1.0 op_sel_hi:[1,0]
    v_pk_add_f32 v[74:75], v[74:75], 1.0 op_sel_hi:[1,0]
    v_pk_add_f32 v[76:77], v[76:77], 1.0 op_sel_hi:[1,0]
    v_pk_add_f32 v[78:79], v[78:79], 1.0 op_sel_hi:[1,0]
    v_rcp_f32 v72, v72
    v_rcp_f32 v73, v73
    v_rcp_f32 v74, v74
    v_rcp_f32 v75, v75
    v_rcp_f32 v76, v76
    v_rcp_f32 v77, v77
    v_rcp_f32 v78, v78
    v_rcp_f32 v79, v79
    v_pk_mul_f32 v[72:73], v[72:73], v[80:81]
    v_pk_mul_f32 v[74:75], v[74:75], v[82:83]
    v_pk_mul_f32 v[76:77], v[76:77], v[84:85]
    v_pk_mul_f32 v[78:79], v[78:79], v[86:87]
    v_cvt_pk_bf16_f32 v80, v72, v73
    v_cvt_pk_bf16_f32 v81, v74, v75
    v_cvt_pk_bf16_f32 v82, v76, v77
    v_cvt_pk_bf16_f32 v83, v78, v79
    s_add_u32 s93, s95, 0
    buffer_store_dwordx4 v[80:83], v14, s[64:67], s93 offen sc1
    v_add_u32 v20, 14336, v22
    v_add_u32 v21, 14336, v23
    v_lshrrev_b32 v61, 5, v1
    s_and_b32 s99, s3, 1
    s_lshl_b32 s99, s99, 2
    v_bfe_u32 v62, v1, 1, 3
    v_xor_b32 v61, v61, v62
    v_xor_b32 v61, s99, v61
    v_and_b32 v62, 31, v1
    v_lshlrev_b32 v62, 7, v62
    v_lshl_add_u32 v60, v61, 4, v62
    v_add_u32 v60, s23, v60
    v_xor_b32 v61, 32, v60
    v_xor_b32 v62, 64, v60
    v_xor_b32 v63, 96, v60
    s_waitcnt vmcnt(0)
    v_mov_b32 v116, 162048
    v_mov_b32 v117, 1
    s_mov_b64 exec, 1
    ds_add_rtn_u32 v117, v116, v117
    s_mov_b64 exec, -1
    s_lshl_b32 s99, s5, 7
    s_lshl_b32 s100, s6, 3
    s_add_u32 s99, s99, s100
    s_add_u32 s99, s99, 0x1141800
    s_waitcnt lgkmcnt(0)
    v_readfirstlane_b32 s100, v117
    s_cmp_eq_u32 s100, 7
    s_cbranch_scc0 K1_NOL3
    v_mov_b32 v116, s12
    v_mov_b32 v117, s13
    s_mov_b64 exec, 1
    buffer_store_dwordx2 v[116:117], off, s[64:67], s99 sc1
    s_mov_b64 exec, -1
K1_NOL3:
    s_add_u32 m0, s23, 0
    s_add_u32 s85, s4, 0
    buffer_load_dwordx4 v22, s[48:51], s85 offen offset:0 lds
    buffer_load_dwordx4 v23, s[48:51], s85 offen offset:1024 lds
    buffer_load_dwordx4 v20, s[48:51], s85 offen offset:2048 lds
    buffer_load_dwordx4 v21, s[48:51], s85 offen offset:3072 lds
    s_add_u32 m0, s23, 4096
    s_add_u32 s85, s4, 32768
    buffer_load_dwordx4 v22, s[48:51], s85 offen offset:0 lds
    buffer_load_dwordx4 v23, s[48:51], s85 offen offset:1024 lds
    buffer_load_dwordx4 v20, s[48:51], s85 offen offset:2048 lds
    buffer_load_dwordx4 v21, s[48:51], s85 offen offset:3072 lds
    s_add_u32 m0, s23, 8192
    s_add_u32 s85, s4, 128
    buffer_load_dwordx4 v22, s[48:51], s85 offen offset:0 lds
    buffer_load_dwordx4 v23, s[48:51], s85 offen offset:1024 lds
    buffer_load_dwordx4 v20, s[48:51], s85 offen offset:2048 lds
    buffer_load_dwordx4 v21, s[48:51], s85 offen offset:3072 lds
    v_mov_b32 v118, 162048
K1_CNT4:
    ds_read_b32 v119, v118
    s_waitcnt lgkmcnt(0)
    v_readfirstlane_b32 s99, v119
    s_cmp_lt_u32 s99, 8
    s_cbranch_scc1 K1_CNT4
    s_add_u32 m0, s23, 81920
    s_add_u32 s85, s4, 32896
    buffer_load_dwordx4 v22, s[48:51], s85 offen offset:0 lds
    buffer_load_dwordx4 v23, s[48:51], s85 offen offset:1024 lds
    buffer_load_dwordx4 v20, s[48:51], s85 offen offset:2048 lds
    buffer_load_dwordx4 v21, s[48:51], s85 offen offset:3072 lds
    s_add_u32 m0, s23, 86016
    s_add_u32 s85, s4, 0
    buffer_load_dwordx4 v22, s[88:91], s85 offen offset:0 lds
    buffer_load_dwordx4 v23, s[88:91], s85 offen offset:1024 lds
    buffer_load_dwordx4 v20, s[88:91], s85 offen offset:2048 lds
    buffer_load_dwordx4 v21, s[88:91], s85 offen offset:3072 lds
    s_add_u32 m0, s23, 90112
    s_add_u32 s85, s4, 32768
    buffer_load_dwordx4 v22, s[88:91], s85 offen offset:0 lds
    buffer_load_dwordx4 v23, s[88:91], s85 offen offset:1024 lds
    buffer_load_dwordx4 v20, s[88:91], s85 offen offset:2048 lds
    buffer_load_dwordx4 v21, s[88:91], s85 offen offset:3072 lds
    v_bfe_u32 v68, v1, 2, 1
    v_lshlrev_b32 v13, 4, v68
    v_bfe_u32 v68, v1, 3, 2
    v_lshl_add_u32 v13, v68, 2, v13
    v_and_b32 v68, 3, v1
    v_add_u32 v13, v13, v68
    s_lshl_b32 s99, s26, 6
    s_lshr_b32 s100, s42, 1
    s_lshl_b32 s100, s100, 5
    s_add_u32 s99, s99, s100
    v_add_u32 v13, s99, v13
    s_lshl_b32 s99, s27, 6
    s_and_b32 s100, s42, 1
    s_lshl_b32 s100, s100, 5
    s_add_u32 s99, s99, s100
    s_lshl_b32 s100, s43, 4
    s_add_u32 s99, s99, s100
    v_lshrrev_b32 v68, 5, v1
    v_lshlrev_b32 v68, 2, v68
    v_add_u32 v68, s99, v68
    v_lshlrev_b32 v69, 1, v68
    v_lshl_add_u32 v68, v13, 10, v69
    v_lshlrev_b32 v12, 1, v68
    v_lshlrev_b32 v13, 3, v13
    s_mov_b32 s80, s24
    s_mov_b32 s81, s25
    s_mov_b32 s82, 0x400
    s_mov_b32 s83, 0x00020000
    buffer_load_dwordx2 v[2:3], v68, s[44:47], 0 offen offset:0
    buffer_load_dwordx2 v[6:7], v69, s[80:83], 0 offen offset:0
    buffer_load_dwordx2 v[4:5], v68, s[44:47], 0 offen offset:16
    buffer_load_dwordx2 v[8:9], v69, s[80:83], 0 offen offset:16
    s_mul_i32 s99, s42, 40960
    s_xor_b32 s100, s43, 1
    s_lshl_b32 s100, s100, 14
    s_add_u32 s99, s99, s100
    v_add_u32 v15, s99, v14
    s_waitcnt vmcnt(24)
    ds_read_b128 a[32:35], v60 offset:0
    ds_read_b128 a[40:43], v61 offset:0
    ds_read_b128 a[48:51], v62 offset:0
    ds_read_b128 a[56:59], v63 offset:0
    s_waitcnt vmcnt(20)
    ds_read_b128 a[36:39], v60 offset:4096
    ds_read_b128 a[44:47], v61 offset:4096
    ds_read_b128 a[52:55], v62 offset:4096
    ds_read_b128 a[60:63], v63 offset:4096
    s_waitcnt vmcnt(16)
    ds_read_b128 a[64:67], v60 offset:8192
    ds_read_b128 a[72:75], v61 offset:8192
    ds_read_b128 a[80:83], v62 offset:8192
    ds_read_b128 a[88:91], v63 offset:8192
    s_waitcnt lgkmcnt(8)
    s_add_u32 m0, s23, 0
    s_add_u32 s85, s4, 128
    buffer_load_dwordx4 v22, s[88:91], s85 offen offset:0 lds
    buffer_load_dwordx4 v23, s[88:91], s85 offen offset:1024 lds
    buffer_load_dwordx4 v20, s[88:91], s85 offen offset:2048 lds
    buffer_load_dwordx4 v21, s[88:91], s85 offen offset:3072 lds
    s_waitcnt lgkmcnt(4)
    s_add_u32 m0, s23, 4096
    s_add_u32 s85, s4, 32896
    buffer_load_dwordx4 v22, s[88:91], s85 offen offset:0 lds
    buffer_load_dwordx4 v23, s[88:91], s85 offen offset:1024 lds
    buffer_load_dwordx4 v20, s[88:91], s85 offen offset:2048 lds
    buffer_load_dwordx4 v21, s[88:91], s85 offen offset:3072 lds
    s_lshr_b32 s99, s26, 1
    s_lshl_b32 s99, s99, 7
    s_add_u32 s99, s99, 0x1141800
    v_and_b32 v67, 15, v1
    v_lshl_add_u32 v66, v67, 3, s99
    buffer_load_dwordx2 v[64:65], v66, s[64:67], 0 offen sc1
    s_waitcnt vmcnt(0)
    s_mov_b32 s93, 0x40000
K1_FCHK5:
    v_cmp_ne_u64 s[0:1], v[64:65], s[12:13]
    s_sub_u32 s93, s93, 1
    s_cmp_eq_u32 s93, 0
    s_cbranch_scc1 K1_FOK6
    s_cmp_eq_u64 s[0:1], 0
    s_cbranch_scc1 K1_FOK6
    s_sleep 1
    buffer_load_dwordx2 v[64:65], v66, s[64:67], 0 offen sc1
    s_waitcnt vmcnt(0)
    s_branch K1_FCHK5
K1_FOK6:
    s_add_u32 s86, s22, 0
    buffer_load_dwordx4 v[24:27], v14, s[52:55], s86 offen offset:0 sc1
    buffer_load_dwordx4 v[28:31], v14, s[52:55], s86 offen offset:1024 sc1
    buffer_load_dwordx4 v[32:35], v14, s[52:55], s86 offen offset:2048 sc1
    buffer_load_dwordx4 v[36:39], v14, s[52:55], s86 offen offset:3072 sc1
    s_add_u32 s86, s22, 8192
    buffer_load_dwordx4 v[40:43], v14, s[52:55], s86 offen offset:0 sc1
    buffer_load_dwordx4 v[44:47], v14, s[52:55], s86 offen offset:1024 sc1
    s_waitcnt vmcnt(4)
    v_mfma_f32_32x32x16_bf16 v[64:79], a[32:35], v[24:27], 0
    v_lshlrev_b32 v0, 16, v2
    v_mfma_f32_32x32x16_bf16 v[80:95], a[36:39], v[24:27], 0
    v_and_b32 v2, 0xffff0000, v2
    v_lshlrev_b32 v10, 16, v6
    v_mfma_f32_32x32x16_bf16 v[96:111], a[32:35], v[28:31], 0
    v_and_b32 v6, 0xffff0000, v6
    v_mul_f32 v0, v0, v10
    v_mfma_f32_32x32x16_bf16 v[112:127], a[36:39], v[28:31], 0
    v_mul_f32 v2, v2, v6
    v_cvt_pk_bf16_f32 v2, v0, v2
    v_add_u32 v60, 81920, v60
    v_add_u32 v61, 81920, v61
    v_add_u32 v62, 81920, v62
    v_add_u32 v63, 81920, v63
    ds_read_b128 a[68:71], v60 offset:0
    ds_read_b128 a[76:79], v61 offset:0
    ds_read_b128 a[84:87], v62 offset:0
    ds_read_b128 a[92:95], v63 offset:0
    buffer_load_dwordx4 v[24:27], v14, s[52:55], s86 offen offset:2048 sc1
    buffer_load_dwordx4 v[28:31], v14, s[52:55], s86 offen offset:3072 sc1
    s_waitcnt vmcnt(4)
    v_mfma_f32_32x32x16_bf16 v[64:79], a[40:43], v[32:35], v[64:79]
    v_and_b32 v6, 0xffff0000, v2
    v_lshlrev_b32 v2, 16, v2
    v_mfma_f32_32x32x16_bf16 v[80:95], a[44:47], v[32:35], v[80:95]
    v_lshlrev_b32 v0, 16, v3
    v_and_b32 v3, 0xffff0000, v3
    v_mfma_f32_32x32x16_bf16 v[96:111], a[40:43], v[36:39], v[96:111]
    v_lshlrev_b32 v10, 16, v7
    v_and_b32 v7, 0xffff0000, v7
    v_mfma_f32_32x32x16_bf16 v[112:127], a[44:47], v[36:39], v[112:127]
    v_mul_f32 v0, v0, v10
    v_mul_f32 v3, v3, v7
    s_add_u32 s86, s22, 16384
    buffer_load_dwordx4 v[32:35], v14, s[52:55], s86 offen offset:0 sc1
    buffer_load_dwordx4 v[36:39], v14, s[52:55], s86 offen offset:1024 sc1
    s_waitcnt vmcnt(4)
    v_mfma_f32_32x32x16_bf16 v[64:79], a[48:51], v[40:43], v[64:79]
    v_cvt_pk_bf16_f32 v3, v0, v3
    v_and_b32 v7, 0xffff0000, v3
    v_mfma_f32_32x32x16_bf16 v[80:95], a[52:55], v[40:43], v[80:95]
    v_lshlrev_b32 v3, 16, v3
    v_lshlrev_b32 v0, 16, v4
    v_mfma_f32_32x32x16_bf16 v[96:111], a[48:51], v[44:47], v[96:111]
    v_and_b32 v4, 0xffff0000, v4
    v_lshlrev_b32 v10, 16, v8
    v_mfma_f32_32x32x16_bf16 v[112:127], a[52:55], v[44:47], v[112:127]
    v_and_b32 v8, 0xffff0000, v8
    v_mul_f32 v0, v0, v10
    ds_read_b128 a[96:99], v60 offset:4096
    ds_read_b128 a[104:107], v61 offset:4096
    ds_read_b128 a[112:115], v62 offset:4096
    ds_read_b128 a[120:123], v63 offset:4096
    buffer_load_dwordx4 v[40:43], v14, s[52:55], s86 offen offset:2048 sc1
    buffer_load_dwordx4 v[44:47], v14, s[52:55], s86 offen offset:3072 sc1
    s_waitcnt vmcnt(4)
    v_mfma_f32_32x32x16_bf16 v[64:79], a[56:59], v[24:27], v[64:79]
    v_mul_f32 v4, v4, v8
    v_cvt_pk_bf16_f32 v4, v0, v4
    v_mfma_f32_32x32x16_bf16 v[80:95], a[60:63], v[24:27], v[80:95]
    v_and_b32 v8, 0xffff0000, v4
    v_lshlrev_b32 v4, 16, v4
    v_mfma_f32_32x32x16_bf16 v[96:111], a[56:59], v[28:31], v[96:111]
    v_lshlrev_b32 v0, 16, v5
    v_and_b32 v5, 0xffff0000, v5
    v_mfma_f32_32x32x16_bf16 v[112:127], a[60:63], v[28:31], v[112:127]
    v_lshlrev_b32 v10, 16, v9
    v_and_b32 v9, 0xffff0000, v9
    s_add_u32 s86, s22, 24576
    buffer_load_dwordx4 v[24:27], v14, s[52:55], s86 offen offset:0 sc1
    buffer_load_dwordx4 v[28:31], v14, s[52:55], s86 offen offset:1024 sc1
    s_waitcnt lgkmcnt(4)
    s_waitcnt vmcnt(4)
    v_mfma_f32_32x32x16_bf16 v[64:79], a[64:67], v[32:35], v[64:79]
    v_mul_f32 v0, v0, v10
    v_mul_f32 v5, v5, v9
    v_mfma_f32_32x32x16_bf16 v[80:95], a[68:71], v[32:35], v[80:95]
    v_cvt_pk_bf16_f32 v5, v0, v5
    v_and_b32 v9, 0xffff0000, v5
    v_mfma_f32_32x32x16_bf16 v[96:111], a[64:67], v[36:39], v[96:111]
    v_lshlrev_b32 v5, 16, v5
    v_mfma_f32_32x32x16_bf16 v[112:127], a[68:71], v[36:39], v[112:127]
    ds_read_b128 a[100:103], v60 offset:8192
    ds_read_b128 a[108:111], v61 offset:8192
    ds_read_b128 a[116:119], v62 offset:8192
    ds_read_b128 a[124:127], v63 offset:8192
    buffer_load_dwordx4 v[32:35], v14, s[52:55], s86 offen offset:2048 sc1
    buffer_load_dwordx4 v[36:39], v14, s[52:55], s86 offen offset:3072 sc1
    s_waitcnt vmcnt(4)
    v_mfma_f32_32x32x16_bf16 v[64:79], a[72:75], v[40:43], v[64:79]
    v_mfma_f32_32x32x16_bf16 v[80:95], a[76:79], v[40:43], v[80:95]
    v_mfma_f32_32x32x16_bf16 v[96:111], a[72:75], v[44:47], v[96:111]
    v_mfma_f32_32x32x16_bf16 v[112:127], a[76:79], v[44:47], v[112:127]
    s_add_u32 s86, s22, 4096
    buffer_load_dwordx4 v[40:43], v14, s[52:55], s86 offen offset:0 sc1
    buffer_load_dwordx4 v[44:47], v14, s[52:55], s86 offen offset:1024 sc1
    s_waitcnt vmcnt(4)
    v_mfma_f32_32x32x16_bf16 v[64:79], a[80:83], v[24:27], v[64:79]
    v_mfma_f32_32x32x16_bf16 v[80:95], a[84:87], v[24:27], v[80:95]
    v_mfma_f32_32x32x16_bf16 v[96:111], a[80:83], v[28:31], v[96:111]
    v_mfma_f32_32x32x16_bf16 v[112:127], a[84:87], v[28:31], v[112:127]
    v_subrev_u32 v60, 81920, v60
    v_subrev_u32 v61, 81920, v61
    v_subrev_u32 v62, 81920, v62
    v_subrev_u32 v63, 81920, v63
    ds_read_b128 a[0:3], v60 offset:0
    ds_read_b128 a[8:11], v61 offset:0
    ds_read_b128 a[16:19], v62 offset:0
    ds_read_b128 a[24:27], v63 offset:0
    buffer_load_dwordx4 v[24:27], v14, s[52:55], s86 offen offset:2048 sc1
    buffer_load_dwordx4 v[28:31], v14, s[52:55], s86 offen offset:3072 sc1
    s_waitcnt vmcnt(4)
    v_mfma_f32_32x32x16_bf16 v[64:79], a[88:91], v[32:35], v[64:79]
    v_mfma_f32_32x32x16_bf16 v[80:95], a[92:95], v[32:35], v[80:95]
    v_mfma_f32_32x32x16_bf16 v[96:111], a[88:91], v[36:39], v[96:111]
    v_mfma_f32_32x32x16_bf16 v[112:127], a[92:95], v[36:39], v[112:127]
    s_add_u32 s86, s22, 12288
    buffer_load_dwordx4 v[32:35], v14, s[52:55], s86 offen offset:0 sc1
    buffer_load_dwordx4 v[36:39], v14, s[52:55], s86 offen offset:1024 sc1
    s_waitcnt lgkmcnt(4)
    s_waitcnt vmcnt(4)
    v_mfma_f32_32x32x16_bf16 v[64:79], a[96:99], v[40:43], v[64:79]
    v_mfma_f32_32x32x16_bf16 v[80:95], a[100:103], v[40:43], v[80:95]
    v_mfma_f32_32x32x16_bf16 v[96:111], a[96:99], v[44:47], v[96:111]
    v_mfma_f32_32x32x16_bf16 v[112:127], a[100:103], v[44:47], v[112:127]
    ds_read_b128 a[4:7], v60 offset:4096
    ds_read_b128 a[12:15], v61 offset:4096
    ds_read_b128 a[20:23], v62 offset:4096
    ds_read_b128 a[28:31], v63 offset:4096
    buffer_load_dwordx4 v[40:43], v14, s[52:55], s86 offen offset:2048 sc1
    buffer_load_dwordx4 v[44:47], v14, s[52:55], s86 offen offset:3072 sc1
    s_waitcnt vmcnt(4)
    v_mfma_f32_32x32x16_bf16 v[64:79], a[104:107], v[24:27], v[64:79]
    s_waitcnt lgkmcnt(0)
    v_mov_b32 v58, 162052
    v_mov_b32 v59, 1
    s_mov_b64 exec, 1
    ds_add_u32 v58, v59
    s_mov_b64 exec, -1
    v_mfma_f32_32x32x16_bf16 v[80:95], a[108:111], v[24:27], v[80:95]
    v_mfma_f32_32x32x16_bf16 v[96:111], a[104:107], v[28:31], v[96:111]
    v_mfma_f32_32x32x16_bf16 v[112:127], a[108:111], v[28:31], v[112:127]
    s_add_u32 s86, s22, 20480
    buffer_load_dwordx4 v[24:27], v14, s[52:55], s86 offen offset:0 sc1
    buffer_load_dwordx4 v[28:31], v14, s[52:55], s86 offen offset:1024 sc1
    s_waitcnt vmcnt(4)
    v_mfma_f32_32x32x16_bf16 v[64:79], a[112:115], v[32:35], v[64:79]
    v_mfma_f32_32x32x16_bf16 v[80:95], a[116:119], v[32:35], v[80:95]
    v_mfma_f32_32x32x16_bf16 v[96:111], a[112:115], v[36:39], v[96:111]
    v_mfma_f32_32x32x16_bf16 v[112:127], a[116:119], v[36:39], v[112:127]
    buffer_load_dwordx4 v[32:35], v14, s[52:55], s86 offen offset:2048 sc1
    buffer_load_dwordx4 v[36:39], v14, s[52:55], s86 offen offset:3072 sc1
    s_waitcnt vmcnt(4)
    v_mfma_f32_32x32x16_bf16 v[64:79], a[120:123], v[40:43], v[64:79]
    v_mfma_f32_32x32x16_bf16 v[80:95], a[124:127], v[40:43], v[80:95]
    v_mfma_f32_32x32x16_bf16 v[96:111], a[120:123], v[44:47], v[96:111]
    v_mfma_f32_32x32x16_bf16 v[112:127], a[124:127], v[44:47], v[112:127]
    s_add_u32 s86, s22, 28672
    buffer_load_dwordx4 v[40:43], v14, s[52:55], s86 offen offset:0 sc1
    buffer_load_dwordx4 v[44:47], v14, s[52:55], s86 offen offset:1024 sc1
    s_waitcnt vmcnt(4)
    v_mfma_f32_32x32x16_bf16 v[64:79], a[0:3], v[24:27], v[64:79]
    v_mfma_f32_32x32x16_bf16 v[80:95], a[4:7], v[24:27], v[80:95]
    v_mfma_f32_32x32x16_bf16 v[96:111], a[0:3], v[28:31], v[96:111]
    v_mfma_f32_32x32x16_bf16 v[112:127], a[4:7], v[28:31], v[112:127]
    buffer_load_dwordx4 v[24:27], v14, s[52:55], s86 offen offset:2048 sc1
    buffer_load_dwordx4 v[28:31], v14, s[52:55], s86 offen offset:3072 sc1
    s_waitcnt vmcnt(4)
    v_mfma_f32_32x32x16_bf16 v[64:79], a[8:11], v[32:35], v[64:79]
    v_mfma_f32_32x32x16_bf16 v[80:95], a[12:15], v[32:35], v[80:95]
    v_mfma_f32_32x32x16_bf16 v[96:111], a[8:11], v[36:39], v[96:111]
    v_mfma_f32_32x32x16_bf16 v[112:127], a[12:15], v[36:39], v[112:127]
    s_waitcnt vmcnt(2)
    v_mfma_f32_32x32x16_bf16 v[64:79], a[16:19], v[40:43], v[64:79]
    v_mfma_f32_32x32x16_bf16 v[80:95], a[20:23], v[40:43], v[80:95]
    v_mfma_f32_32x32x16_bf16 v[96:111], a[16:19], v[44:47], v[96:111]
    v_mfma_f32_32x32x16_bf16 v[112:127], a[20:23], v[44:47], v[112:127]
    s_waitcnt vmcnt(0)
    v_mfma_f32_32x32x16_bf16 v[64:79], a[24:27], v[24:27], v[64:79]
    v_mfma_f32_32x32x16_bf16 v[80:95], a[28:31], v[24:27], v[80:95]
    v_mfma_f32_32x32x16_bf16 v[96:111], a[24:27], v[28:31], v[96:111]
    v_mfma_f32_32x32x16_bf16 v[112:127], a[28:31], v[28:31], v[112:127]
    s_branch K1_EPI
K1_ROLE1:
    v_xor_b32 v18, 64, v17
    v_xor_b32 v19, 96, v17
    v_xor_b32 v17, 32, v17
    s_setprio 1
    v_mov_b32 v15, 0
    s_lshl_b32 s99, s42, 4
    s_mov_b64 s[10:11], 0xffff
    s_lshl_b64 s[10:11], s[10:11], s99
    s_waitcnt vmcnt(0)
    s_barrier
    ds_read_b128 a[0:3], v10 offset:0
    ds_read_b64_tr_b16 v[104:105], v17 offset:0
    ds_read_b64_tr_b16 v[106:107], v17 offset:512
    ds_read_b64_tr_b16 v[108:109], v18 offset:0
    ds_read_b64_tr_b16 v[110:111], v18 offset:512
    ds_read_b64_tr_b16 v[112:113], v19 offset:0
    ds_read_b64_tr_b16 v[114:115], v19 offset:512
    ds_read_b128 a[4:7], v11 offset:0
    ds_read_b64_tr_b16 v[116:117], v17 offset:2048
    ds_read_b64_tr_b16 v[118:119], v17 offset:2560
    ds_read_b64_tr_b16 v[120:121], v18 offset:2048
    ds_read_b64_tr_b16 v[122:123], v18 offset:2560
    ds_read_b64_tr_b16 v[124:125], v19 offset:2048
    ds_read_b64_tr_b16 v[126:127], v19 offset:2560
    s_waitcnt lgkmcnt(7)
    v_mfma_f32_32x32x16_bf16 v[24:39], v[104:107], a[0:3], 0
    ds_read_b128 a[8:11], v12 offset:0
    ds_read_b64_tr_b16 v[104:105], v17 offset:4096
    ds_read_b64_tr_b16 v[106:107], v17 offset:4608
    s_add_u32 s85, s4, 2
    s_and_b32 s85, s85, 7
    s_lshl_b32 s87, s85, 7
    s_mul_i32 s85, s85, 229376
    s_add_u32 m0, s96, 81920
    s_add_u32 s93, s87, 0
    buffer_load_dwordx4 v4, s[44:47], s93 offen lds
    s_add_u32 m0, s97, 106496
    s_add_u32 s93, s85, 0
    buffer_load_dwordx4 v7, s[52:55], s93 offen lds
    v_mfma_f32_32x32x16_bf16 v[40:55], v[108:111], a[0:3], 0
    ds_read_b64_tr_b16 v[108:109], v18 offset:4096
    ds_read_b64_tr_b16 v[110:111], v18 offset:4608
    s_add_u32 m0, s96, 82944
    s_add_u32 s93, s87, 0
    buffer_load_dwordx4 v5, s[44:47], s93 offen lds
    s_add_u32 m0, s97, 114688
    s_add_u32 s93, s85, 0
    buffer_load_dwordx4 v8, s[56:59], s93 offen lds
    v_mfma_f32_32x32x16_bf16 v[56:71], v[112:115], a[0:3], 0
    ds_read_b64_tr_b16 v[112:113], v19 offset:4096
    ds_read_b64_tr_b16 v[114:115], v19 offset:4608
    s_add_u32 m0, s97, 98304
    s_add_u32 s93, s87, 0
    buffer_load_dwordx4 v6, s[48:51], s93 offen lds
    s_waitcnt lgkmcnt(7)
    v_mfma_f32_32x32x16_bf16 v[24:39], v[116:119], a[4:7], v[24:39]
    ds_read_b128 a[12:15], v13 offset:0
    ds_read_b64_tr_b16 v[116:117], v17 offset:6144
    ds_read_b64_tr_b16 v[118:119], v17 offset:6656
    s_and_b32 s99, s2, 7
    s_lshr_b32 s26, s99, 2
    s_lshl_b32 s26, s26, 1
    s_and_b32 s100, s99, 1
    s_add_u32 s26, s26, s100
    s_lshl_b32 s26, s26, 3
    s_add_u32 s26, s26, s94
    s_bfe_u32 s27, s99, 0x10001
    s_lshl_b32 s27, s27, 2
    s_add_u32 s27, s27, s95
    s_mul_i32 s98, s42, 3072
    s_mov_b32 s64, s40
    s_mov_b32 s65, s41
    s_mov_b32 s66, 0x1400000
    s_mov_b32 s67, 0x00020000
    s_mov_b32 s92, 0xbfb8aa3b
    s_lshl_b32 s99, s5, 1
    s_lshr_b32 s100, s42, 1
    s_add_u32 s99, s99, s100
    s_mul_i32 s99, s99, 360448
    s_and_b32 s100, s42, 1
    s_lshl_b32 s100, s100, 10
    s_add_u32 s99, s99, s100
    s_lshl_b32 s100, s6, 13
    s_add_u32 s94, s99, s100
    s_add_u32 s84, s94, 131072
    s_mul_i32 s100, s6, 6144
    s_add_u32 s95, s99, s100
    s_add_u32 s95, s95, 262144
    s_mov_b32 s72, s38
    s_mov_b32 s73, s39
    s_mov_b32 s74, 0x100
    s_mov_b32 s75, 0x00020000
    v_mfma_f32_32x32x16_bf16 v[40:55], v[120:123], a[4:7], v[40:55]
    ds_read_b64_tr_b16 v[120:121], v18 offset:6144
    ds_read_b64_tr_b16 v[122:123], v18 offset:6656
    v_mfma_f32_32x32x16_bf16 v[56:71], v[124:127], a[4:7], v[56:71]
    ds_read_b64_tr_b16 v[124:125], v19 offset:6144
    ds_read_b64_tr_b16 v[126:127], v19 offset:6656
    s_barrier
    s_waitcnt lgkmcnt(7)
    v_mfma_f32_32x32x16_bf16 v[24:39], v[104:107], a[8:11], v[24:39]
    ds_read_b128 a[16:19], v10 offset:40960
    ds_read_b64_tr_b16 v[104:105], v17 offset:40960
    ds_read_b64_tr_b16 v[106:107], v17 offset:41472
    s_add_u32 s85, s4, 3
    s_and_b32 s85, s85, 7
    s_lshl_b32 s87, s85, 7
    s_mul_i32 s85, s85, 229376
    s_add_u32 m0, s96, 122880
    s_add_u32 s93, s87, 0
    buffer_load_dwordx4 v4, s[44:47], s93 offen lds
    s_add_u32 m0, s97, 147456
    s_add_u32 s93, s85, 0
    buffer_load_dwordx4 v7, s[52:55], s93 offen lds
    v_mfma_f32_32x32x16_bf16 v[40:55], v[108:111], a[8:11], v[40:55]
    ds_read_b64_tr_b16 v[108:109], v18 offset:40960
    ds_read_b64_tr_b16 v[110:111], v18 offset:41472
    s_add_u32 m0, s96, 123904
    s_add_u32 s93, s87, 0
    buffer_load_dwordx4 v5, s[44:47], s93 offen lds
    s_add_u32 m0, s97, 155648
    s_add_u32 s93, s85, 0
    buffer_load_dwordx4 v8, s[56:59], s93 offen lds
    v_mfma_f32_32x32x16_bf16 v[56:71], v[112:115], a[8:11], v[56:71]
    ds_read_b64_tr_b16 v[112:113], v19 offset:40960
    ds_read_b64_tr_b16 v[114:115], v19 offset:41472
    s_add_u32 m0, s97, 139264
    s_add_u32 s93, s87, 0
    buffer_load_dwordx4 v6, s[48:51], s93 offen lds
    v_mov_b32 v2, s28
    v_mov_b32 v3, s29
    v_cmp_le_u32 vcc, 32, v1
    v_mov_b32 v20, s30
    v_mov_b32 v21, s31
    v_cndmask_b32 v2, v2, v20, vcc
    v_cndmask_b32 v3, v3, v21, vcc
    v_bfe_u32 v20, v1, 1, 4
    v_mul_u32_u24 v20, 3584, v20
    v_and_b32 v21, 1, v1
    v_mul_u32_u24 v21, 80, v21
    s_and_b32 s99, s5, 7
    s_mul_i32 s99, s99, 57344
    s_mul_i32 s100, s6, 96
    s_add_u32 s99, s99, s100
    s_add_u32 s99, s99, 2048
    v_add3_u32 v20, v20, v21, s99
    v_mov_b32 v15, 458752
    v_add_co_u32 v2, vcc, v20, v2
    s_nop 1
    v_addc_co_u32 v3, vcc, 0, v3, vcc
    s_mov_b64 exec, s[10:11]
    global_load_dword v0, v[2:3], off
    s_mov_b64 exec, -1
    v_add_co_u32 v2, vcc, v15, v2
    s_nop 1
    v_addc_co_u32 v3, vcc, 0, v3, vcc
    s_waitcnt lgkmcnt(7)
    v_mfma_f32_32x32x16_bf16 v[24:39], v[116:119], a[12:15], v[24:39]
    ds_read_b128 a[20:23], v11 offset:40960
    ds_read_b64_tr_b16 v[116:117], v17 offset:43008
    ds_read_b64_tr_b16 v[118:119], v17 offset:43520
    v_mfma_f32_32x32x16_bf16 v[40:55], v[120:123], a[12:15], v[40:55]
    ds_read_b64_tr_b16 v[120:121], v18 offset:43008
    ds_read_b64_tr_b16 v[122:123], v18 offset:43520
    v_mfma_f32_32x32x16_bf16 v[56:71], v[124:127], a[12:15], v[56:71]
    ds_read_b64_tr_b16 v[124:125], v19 offset:43008
    ds_read_b64_tr_b16 v[126:127], v19 offset:43520
    s_waitcnt lgkmcnt(7)
    v_mfma_f32_32x32x16_bf16 v[24:39], v[104:107], a[16:19], v[24:39]
    ds_read_b128 a[24:27], v12 offset:40960
    ds_read_b64_tr_b16 v[104:105], v17 offset:45056
    ds_read_b64_tr_b16 v[106:107], v17 offset:45568
    v_mfma_f32_32x32x16_bf16 v[40:55], v[108:111], a[16:19], v[40:55]
    ds_read_b64_tr_b16 v[108:109], v18 offset:45056
    ds_read_b64_tr_b16 v[110:111], v18 offset:45568
    v_mfma_f32_32x32x16_bf16 v[56:71], v[112:115], a[16:19], v[56:71]
    ds_read_b64_tr_b16 v[112:113], v19 offset:45056
    ds_read_b64_tr_b16 v[114:115], v19 offset:45568
    s_waitcnt lgkmcnt(7)
    v_mfma_f32_32x32x16_bf16 v[24:39], v[116:119], a[20:23], v[24:39]
    ds_read_b128 a[28:31], v13 offset:40960
    ds_read_b64_tr_b16 v[116:117], v17 offset:47104
    ds_read_b64_tr_b16 v[118:119], v17 offset:47616
    v_mfma_f32_32x32x16_bf16 v[40:55], v[120:123], a[20:23], v[40:55]
    ds_read_b64_tr_b16 v[120:121], v18 offset:47104
    ds_read_b64_tr_b16 v[122:123], v18 offset:47616
    v_mfma_f32_32x32x16_bf16 v[56:71], v[124:127], a[20:23], v[56:71]
    ds_read_b64_tr_b16 v[124:125], v19 offset:47104
    ds_read_b64_tr_b16 v[126:127], v19 offset:47616
    s_waitcnt vmcnt(6)
    s_barrier
    s_waitcnt lgkmcnt(7)
    v_mfma_f32_32x32x16_bf16 v[24:39], v[104:107], a[24:27], v[24:39]
    v_add_u32 v10, 81920, v10
    v_add_u32 v11, 81920, v11
    v_add_u32 v12, 81920, v12
    v_add_u32 v13, 81920, v13
    v_add_u32 v17, 81920, v17
    v_add_u32 v18, 81920, v18
    v_add_u32 v19, 81920, v19
    ds_read_b128 a[32:35], v10 offset:0
    ds_read_b64_tr_b16 v[104:105], v17 offset:0
    ds_read_b64_tr_b16 v[106:107], v17 offset:512
    s_add_u32 s85, s4, 4
    s_and_b32 s85, s85, 7
    s_lshl_b32 s87, s85, 7
    s_mul_i32 s85, s85, 229376
    s_add_u32 m0, s96, 0
    s_add_u32 s93, s87, 0
    buffer_load_dwordx4 v4, s[44:47], s93 offen lds
    s_add_u32 m0, s97, 24576
    s_add_u32 s93, s85, 0
    buffer_load_dwordx4 v7, s[52:55], s93 offen lds
    v_mfma_f32_32x32x16_bf16 v[40:55], v[108:111], a[24:27], v[40:55]
    ds_read_b64_tr_b16 v[108:109], v18 offset:0
    ds_read_b64_tr_b16 v[110:111], v18 offset:512
    s_add_u32 m0, s96, 1024
    s_add_u32 s93, s87, 0
    buffer_load_dwordx4 v5, s[44:47], s93 offen lds
    s_add_u32 m0, s97, 32768
    s_add_u32 s93, s85, 0
    buffer_load_dwordx4 v8, s[56:59], s93 offen lds
    v_mfma_f32_32x32x16_bf16 v[56:71], v[112:115], a[24:27], v[56:71]
    ds_read_b64_tr_b16 v[112:113], v19 offset:0
    ds_read_b64_tr_b16 v[114:115], v19 offset:512
    s_add_u32 m0, s97, 16384
    s_add_u32 s93, s87, 0
    buffer_load_dwordx4 v6, s[48:51], s93 offen lds
    s_mov_b64 exec, s[10:11]
    global_load_dword v0, v[2:3], off
    s_mov_b64 exec, -1
    v_add_co_u32 v2, vcc, v15, v2
    s_nop 1
    v_addc_co_u32 v3, vcc, 0, v3, vcc
    s_waitcnt lgkmcnt(7)
    v_mfma_f32_32x32x16_bf16 v[24:39], v[116:119], a[28:31], v[24:39]
    ds_read_b128 a[36:39], v11 offset:0
    ds_read_b64_tr_b16 v[116:117], v17 offset:2048
    ds_read_b64_tr_b16 v[118:119], v17 offset:2560
    v_mfma_f32_32x32x16_bf16 v[40:55], v[120:123], a[28:31], v[40:55]
    ds_read_b64_tr_b16 v[120:121], v18 offset:2048
    ds_read_b64_tr_b16 v[122:123], v18 offset:2560
    v_mfma_f32_32x32x16_bf16 v[56:71], v[124:127], a[28:31], v[56:71]
    ds_read_b64_tr_b16 v[124:125], v19 offset:2048
    ds_read_b64_tr_b16 v[126:127], v19 offset:2560
    s_waitcnt lgkmcnt(7)
    v_mfma_f32_32x32x16_bf16 v[24:39], v[104:107], a[32:35], v[24:39]
    ds_read_b128 a[40:43], v12 offset:0
    ds_read_b64_tr_b16 v[104:105], v17 offset:4096
    ds_read_b64_tr_b16 v[106:107], v17 offset:4608
    v_mfma_f32_32x32x16_bf16 v[40:55], v[108:111], a[32:35], v[40:55]
    ds_read_b64_tr_b16 v[108:109], v18 offset:4096
    ds_read_b64_tr_b16 v[110:111], v18 offset:4608
    v_mfma_f32_32x32x16_bf16 v[56:71], v[112:115], a[32:35], v[56:71]
    ds_read_b64_tr_b16 v[112:113], v19 offset:4096
    ds_read_b64_tr_b16 v[114:115], v19 offset:4608
    s_waitcnt lgkmcnt(7)
    v_mfma_f32_32x32x16_bf16 v[24:39], v[116:119], a[36:39], v[24:39]
    ds_read_b128 a[44:47], v13 offset:0
    ds_read_b64_tr_b16 v[116:117], v17 offset:6144
    ds_read_b64_tr_b16 v[118:119], v17 offset:6656
    v_mfma_f32_32x32x16_bf16 v[40:55], v[120:123], a[36:39], v[40:55]
    ds_read_b64_tr_b16 v[120:121], v18 offset:6144
    ds_read_b64_tr_b16 v[122:123], v18 offset:6656
    v_mfma_f32_32x32x16_bf16 v[56:71], v[124:127], a[36:39], v[56:71]
    ds_read_b64_tr_b16 v[124:125], v19 offset:6144
    ds_read_b64_tr_b16 v[126:127], v19 offset:6656
    s_waitcnt vmcnt(7)
    s_barrier
    s_waitcnt lgkmcnt(7)
    v_mfma_f32_32x32x16_bf16 v[24:39], v[104:107], a[40:43], v[24:39]
    ds_read_b128 a[48:51], v10 offset:40960
    ds_read_b64_tr_b16 v[104:105], v17 offset:40960
    ds_read_b64_tr_b16 v[106:107], v17 offset:41472
    s_add_u32 s85, s4, 5
    s_and_b32 s85, s85, 7
    s_lshl_b32 s87, s85, 7
    s_mul_i32 s85, s85, 229376
    s_add_u32 m0, s96, 40960
    s_add_u32 s93, s87, 0
    buffer_load_dwordx4 v4, s[44:47], s93 offen lds
    s_add_u32 m0, s97, 65536
    s_add_u32 s93, s85, 0
    buffer_load_dwordx4 v7, s[52:55], s93 offen lds
    v_mfma_f32_32x32x16_bf16 v[40:55], v[108:111], a[40:43], v[40:55]
    ds_read_b64_tr_b16 v[108:109], v18 offset:40960
    ds_read_b64_tr_b16 v[110:111], v18 offset:41472
    s_add_u32 m0, s96, 41984
    s_add_u32 s93, s87, 0
    buffer_load_dwordx4 v5, s[44:47], s93 offen lds
    s_add_u32 m0, s97, 73728
    s_add_u32 s93, s85, 0
    buffer_load_dwordx4 v8, s[56:59], s93 offen lds
    v_mfma_f32_32x32x16_bf16 v[56:71], v[112:115], a[40:43], v[56:71]
    ds_read_b64_tr_b16 v[112:113], v19 offset:40960
    ds_read_b64_tr_b16 v[114:115], v19 offset:41472
    s_add_u32 m0, s97, 57344
    s_add_u32 s93, s87, 0
    buffer_load_dwordx4 v6, s[48:51], s93 offen lds
    s_mov_b64 exec, s[10:11]
    global_load_dword v0, v[2:3], off
    s_mov_b64 exec, -1
    v_add_co_u32 v2, vcc, v15, v2
    s_nop 1
    v_addc_co_u32 v3, vcc, 0, v3, vcc
    s_waitcnt lgkmcnt(7)
    v_mfma_f32_32x32x16_bf16 v[24:39], v[116:119], a[44:47], v[24:39]
    ds_read_b128 a[52:55], v11 offset:40960
    ds_read_b64_tr_b16 v[116:117], v17 offset:43008
    ds_read_b64_tr_b16 v[118:119], v17 offset:43520
    v_mfma_f32_32x32x16_bf16 v[40:55], v[120:123], a[44:47], v[40:55]
    ds_read_b64_tr_b16 v[120:121], v18 offset:43008
    ds_read_b64_tr_b16 v[122:123], v18 offset:43520
    v_mfma_f32_32x32x16_bf16 v[56:71], v[124:127], a[44:47], v[56:71]
    ds_read_b64_tr_b16 v[124:125], v19 offset:43008
    ds_read_b64_tr_b16 v[126:127], v19 offset:43520
    s_waitcnt lgkmcnt(7)
    v_mfma_f32_32x32x16_bf16 v[24:39], v[104:107], a[48:51], v[24:39]
    ds_read_b128 a[56:59], v12 offset:40960
    ds_read_b64_tr_b16 v[104:105], v17 offset:45056
    ds_read_b64_tr_b16 v[106:107], v17 offset:45568
    v_mfma_f32_32x32x16_bf16 v[40:55], v[108:111], a[48:51], v[40:55]
    ds_read_b64_tr_b16 v[108:109], v18 offset:45056
    ds_read_b64_tr_b16 v[110:111], v18 offset:45568
    v_mfma_f32_32x32x16_bf16 v[56:71], v[112:115], a[48:51], v[56:71]
    ds_read_b64_tr_b16 v[112:113], v19 offset:45056
    ds_read_b64_tr_b16 v[114:115], v19 offset:45568
    s_waitcnt lgkmcnt(7)
    v_mfma_f32_32x32x16_bf16 v[24:39], v[116:119], a[52:55], v[24:39]
    ds_read_b128 a[60:63], v13 offset:40960
    ds_read_b64_tr_b16 v[116:117], v17 offset:47104
    ds_read_b64_tr_b16 v[118:119], v17 offset:47616
    v_mfma_f32_32x32x16_bf16 v[40:55], v[120:123], a[52:55], v[40:55]
    ds_read_b64_tr_b16 v[120:121], v18 offset:47104
    ds_read_b64_tr_b16 v[122:123], v18 offset:47616
    v_mfma_f32_32x32x16_bf16 v[56:71], v[124:127], a[52:55], v[56:71]
    ds_read_b64_tr_b16 v[124:125], v19 offset:47104
    ds_read_b64_tr_b16 v[126:127], v19 offset:47616
    s_waitcnt vmcnt(7)
    s_barrier
    s_waitcnt lgkmcnt(7)
    v_mfma_f32_32x32x16_bf16 v[24:39], v[104:107], a[56:59], v[24:39]
    v_subrev_u32 v10, 81920, v10
    v_subrev_u32 v11, 81920, v11
    v_subrev_u32 v12, 81920, v12
    v_subrev_u32 v13, 81920, v13
    v_subrev_u32 v17, 81920, v17
    v_subrev_u32 v18, 81920, v18
    v_subrev_u32 v19, 81920, v19
    ds_read_b128 a[64:67], v10 offset:0
    ds_read_b64_tr_b16 v[104:105], v17 offset:0
    ds_read_b64_tr_b16 v[106:107], v17 offset:512
    s_add_u32 s85, s4, 6
    s_and_b32 s85, s85, 7
    s_lshl_b32 s87, s85, 7
    s_mul_i32 s85, s85, 229376
    s_add_u32 m0, s96, 81920
    s_add_u32 s93, s87, 0
    buffer_load_dwordx4 v4, s[44:47], s93 offen lds
    s_add_u32 m0, s97, 106496
    s_add_u32 s93, s85, 0
    buffer_load_dwordx4 v7, s[52:55], s93 offen lds
    v_mfma_f32_32x32x16_bf16 v[40:55], v[108:111], a[56:59], v[40:55]
    ds_read_b64_tr_b16 v[108:109], v18 offset:0
    ds_read_b64_tr_b16 v[110:111], v18 offset:512
    s_add_u32 m0, s96, 82944
    s_add_u32 s93, s87, 0
    buffer_load_dwordx4 v5, s[44:47], s93 offen lds
    s_add_u32 m0, s97, 114688
    s_add_u32 s93, s85, 0
    buffer_load_dwordx4 v8, s[56:59], s93 offen lds
    v_mfma_f32_32x32x16_bf16 v[56:71], v[112:115], a[56:59], v[56:71]
    ds_read_b64_tr_b16 v[112:113], v19 offset:0
    ds_read_b64_tr_b16 v[114:115], v19 offset:512
    s_add_u32 m0, s97, 98304
    s_add_u32 s93, s87, 0
    buffer_load_dwordx4 v6, s[48:51], s93 offen lds
    s_mov_b64 exec, s[10:11]
    global_load_dword v0, v[2:3], off
    s_mov_b64 exec, -1
    v_add_co_u32 v2, vcc, v15, v2
    s_nop 1
    v_addc_co_u32 v3, vcc, 0, v3, vcc
    s_waitcnt lgkmcnt(7)
    v_mfma_f32_32x32x16_bf16 v[24:39], v[116:119], a[60:63], v[24:39]
    ds_read_b128 a[68:71], v11 offset:0
    ds_read_b64_tr_b16 v[116:117], v17 offset:2048
    ds_read_b64_tr_b16 v[118:119], v17 offset:2560
    v_mfma_f32_32x32x16_bf16 v[40:55], v[120:123], a[60:63], v[40:55]
    ds_read_b64_tr_b16 v[120:121], v18 offset:2048
    ds_read_b64_tr_b16 v[122:123], v18 offset:2560
    v_mfma_f32_32x32x16_bf16 v[56:71], v[124:127], a[60:63], v[56:71]
    ds_read_b64_tr_b16 v[124:125], v19 offset:2048
    ds_read_b64_tr_b16 v[126:127], v19 offset:2560
    s_waitcnt lgkmcnt(7)
    v_mfma_f32_32x32x16_bf16 v[24:39], v[104:107], a[64:67], v[24:39]
    ds_read_b128 a[72:75], v12 offset:0
    ds_read_b64_tr_b16 v[104:105], v17 offset:4096
    ds_read_b64_tr_b16 v[106:107], v17 offset:4608
    v_mfma_f32_32x32x16_bf16 v[40:55], v[108:111], a[64:67], v[40:55]
    ds_read_b64_tr_b16 v[108:109], v18 offset:4096
    ds_read_b64_tr_b16 v[110:111], v18 offset:4608
    v_mfma_f32_32x32x16_bf16 v[56:71], v[112:115], a[64:67], v[56:71]
    ds_read_b64_tr_b16 v[112:113], v19 offset:4096
    ds_read_b64_tr_b16 v[114:115], v19 offset:4608
    s_waitcnt lgkmcnt(7)
    v_mfma_f32_32x32x16_bf16 v[24:39], v[116:119], a[68:71], v[24:39]
    ds_read_b128 a[76:79], v13 offset:0
    ds_read_b64_tr_b16 v[116:117], v17 offset:6144
    ds_read_b64_tr_b16 v[118:119], v17 offset:6656
    v_mfma_f32_32x32x16_bf16 v[40:55], v[120:123], a[68:71], v[40:55]
    ds_read_b64_tr_b16 v[120:121], v18 offset:6144
    ds_read_b64_tr_b16 v[122:123], v18 offset:6656
    v_mfma_f32_32x32x16_bf16 v[56:71], v[124:127], a[68:71], v[56:71]
    ds_read_b64_tr_b16 v[124:125], v19 offset:6144
    ds_read_b64_tr_b16 v[126:127], v19 offset:6656
    s_waitcnt vmcnt(7)
    s_barrier
    s_waitcnt lgkmcnt(7)
    v_mfma_f32_32x32x16_bf16 v[24:39], v[104:107], a[72:75], v[24:39]
    ds_read_b128 a[80:83], v10 offset:40960
    ds_read_b64_tr_b16 v[104:105], v17 offset:40960
    ds_read_b64_tr_b16 v[106:107], v17 offset:41472
    s_add_u32 s85, s4, 7
    s_and_b32 s85, s85, 7
    s_lshl_b32 s87, s85, 7
    s_mul_i32 s85, s85, 229376
    s_add_u32 m0, s96, 122880
    s_add_u32 s93, s87, 0
    buffer_load_dwordx4 v4, s[44:47], s93 offen lds
    s_add_u32 m0, s97, 147456
    s_add_u32 s93, s85, 0
    buffer_load_dwordx4 v7, s[52:55], s93 offen lds
    v_mfma_f32_32x32x16_bf16 v[40:55], v[108:111], a[72:75], v[40:55]
    ds_read_b64_tr_b16 v[108:109], v18 offset:40960
    ds_read_b64_tr_b16 v[110:111], v18 offset:41472
    s_add_u32 m0, s96, 123904
    s_add_u32 s93, s87, 0
    buffer_load_dwordx4 v5, s[44:47], s93 offen lds
    s_add_u32 m0, s97, 155648
    s_add_u32 s93, s85, 0
    buffer_load_dwordx4 v8, s[56:59], s93 offen lds
    v_mfma_f32_32x32x16_bf16 v[56:71], v[112:115], a[72:75], v[56:71]
    ds_read_b64_tr_b16 v[112:113], v19 offset:40960
    ds_read_b64_tr_b16 v[114:115], v19 offset:41472
    s_add_u32 m0, s97, 139264
    s_add_u32 s93, s87, 0
    buffer_load_dwordx4 v6, s[48:51], s93 offen lds
    v_min_u32 v9, 55, v1
    s_lshr_b32 s99, s2, 5
    s_mul_i32 s99, s99, 229376
    s_lshl_b32 s100, s27, 7
    s_add_u32 s99, s99, s100
    v_lshl_add_u32 v9, v9, 10, s99
    v_mov_b32 v15, 57344
    v_mov_b32 v3, s33
    v_add_co_u32 v2, vcc, s32, v9
    s_nop 1
    v_addc_co_u32 v3, vcc, 0, v3, vcc
    s_mov_b64 exec, s[10:11]
    global_load_dword v0, v[2:3], off
    s_mov_b64 exec, -1
    v_add_co_u32 v2, vcc, v15, v2
    s_nop 1
    v_addc_co_u32 v3, vcc, 0, v3, vcc
    s_waitcnt lgkmcnt(7)
    v_mfma_f32_32x32x16_bf16 v[24:39], v[116:119], a[76:79], v[24:39]
    ds_read_b128 a[84:87], v11 offset:40960
    ds_read_b64_tr_b16 v[116:117], v17 offset:43008
    ds_read_b64_tr_b16 v[118:119], v17 offset:43520
    s_mov_b64 exec, s[10:11]
    global_load_dword v0, v[2:3], off
    s_mov_b64 exec, -1
    v_add_co_u32 v2, vcc, v15, v2
    s_nop 1
    v_addc_co_u32 v3, vcc, 0, v3, vcc
    buffer_load_dwordx2 v[20:21], off, s[72:75], 0 sc1
    v_mfma_f32_32x32x16_bf16 v[40:55], v[120:123], a[76:79], v[40:55]
    ds_read_b64_tr_b16 v[120:121], v18 offset:43008
    ds_read_b64_tr_b16 v[122:123], v18 offset:43520
    v_mfma_f32_32x32x16_bf16 v[56:71], v[124:127], a[76:79], v[56:71]
    ds_read_b64_tr_b16 v[124:125], v19 offset:43008
    ds_read_b64_tr_b16 v[126:127], v19 offset:43520
    s_waitcnt lgkmcnt(7)
    v_mfma_f32_32x32x16_bf16 v[24:39], v[104:107], a[80:83], v[24:39]
    ds_read_b128 a[88:91], v12 offset:40960
    ds_read_b64_tr_b16 v[104:105], v17 offset:45056
    ds_read_b64_tr_b16 v[106:107], v17 offset:45568
    v_mfma_f32_32x32x16_bf16 v[40:55], v[108:111], a[80:83], v[40:55]
    ds_read_b64_tr_b16 v[108:109], v18 offset:45056
    ds_read_b64_tr_b16 v[110:111], v18 offset:45568
    v_mfma_f32_32x32x16_bf16 v[56:71], v[112:115], a[80:83], v[56:71]
    ds_read_b64_tr_b16 v[112:113], v19 offset:45056
    ds_read_b64_tr_b16 v[114:115], v19 offset:45568
    s_waitcnt lgkmcnt(7)
    v_mfma_f32_32x32x16_bf16 v[24:39], v[116:119], a[84:87], v[24:39]
    ds_read_b128 a[92:95], v13 offset:40960
    ds_read_b64_tr_b16 v[116:117], v17 offset:47104
    ds_read_b64_tr_b16 v[118:119], v17 offset:47616
    v_mfma_f32_32x32x16_bf16 v[40:55], v[120:123], a[84:87], v[40:55]
    ds_read_b64_tr_b16 v[120:121], v18 offset:47104
    ds_read_b64_tr_b16 v[122:123], v18 offset:47616
    v_mfma_f32_32x32x16_bf16 v[56:71], v[124:127], a[84:87], v[56:71]
    ds_read_b64_tr_b16 v[124:125], v19 offset:47104
    ds_read_b64_tr_b16 v[126:127], v19 offset:47616
    s_waitcnt vmcnt(9)
    s_barrier
    s_waitcnt lgkmcnt(7)
    v_mfma_f32_32x32x16_bf16 v[24:39], v[104:107], a[88:91], v[24:39]
    v_add_u32 v10, 81920, v10
    v_add_u32 v11, 81920, v11
    v_add_u32 v12, 81920, v12
    v_add_u32 v13, 81920, v13
    v_add_u32 v17, 81920, v17
    v_add_u32 v18, 81920, v18
    v_add_u32 v19, 81920, v19
    ds_read_b128 a[96:99], v10 offset:0
    ds_read_b64_tr_b16 v[104:105], v17 offset:0
    ds_read_b64_tr_b16 v[106:107], v17 offset:512
    s_mov_b64 exec, s[10:11]
    global_load_dword v0, v[2:3], off
    s_mov_b64 exec, -1
    v_add_co_u32 v2, vcc, v15, v2
    s_nop 1
    v_addc_co_u32 v3, vcc, 0, v3, vcc
    v_mfma_f32_32x32x16_bf16 v[40:55], v[108:111], a[88:91], v[40:55]
    ds_read_b64_tr_b16 v[108:109], v18 offset:0
    ds_read_b64_tr_b16 v[110:111], v18 offset:512
    v_mfma_f32_32x32x16_bf16 v[56:71], v[112:115], a[88:91], v[56:71]
    ds_read_b64_tr_b16 v[112:113], v19 offset:0
    ds_read_b64_tr_b16 v[114:115], v19 offset:512
    s_waitcnt lgkmcnt(7)
    v_mfma_f32_32x32x16_bf16 v[24:39], v[116:119], a[92:95], v[24:39]
    ds_read_b128 a[100:103], v11 offset:0
    ds_read_b64_tr_b16 v[116:117], v17 offset:2048
    ds_read_b64_tr_b16 v[118:119], v17 offset:2560
    v_mfma_f32_32x32x16_bf16 v[40:55], v[120:123], a[92:95], v[40:55]
    ds_read_b64_tr_b16 v[120:121], v18 offset:2048
    ds_read_b64_tr_b16 v[122:123], v18 offset:2560
    v_mfma_f32_32x32x16_bf16 v[56:71], v[124:127], a[92:95], v[56:71]
    ds_read_b64_tr_b16 v[124:125], v19 offset:2048
    ds_read_b64_tr_b16 v[126:127], v19 offset:2560
    s_waitcnt lgkmcnt(7)
    v_mfma_f32_32x32x16_bf16 v[24:39], v[104:107], a[96:99], v[24:39]
    ds_read_b128 a[104:107], v12 offset:0
    ds_read_b64_tr_b16 v[104:105], v17 offset:4096
    ds_read_b64_tr_b16 v[106:107], v17 offset:4608
    v_mfma_f32_32x32x16_bf16 v[40:55], v[108:111], a[96:99], v[40:55]
    ds_read_b64_tr_b16 v[108:109], v18 offset:4096
    ds_read_b64_tr_b16 v[110:111], v18 offset:4608
    v_mfma_f32_32x32x16_bf16 v[56:71], v[112:115], a[96:99], v[56:71]
    ds_read_b64_tr_b16 v[112:113], v19 offset:4096
    ds_read_b64_tr_b16 v[114:115], v19 offset:4608
    s_waitcnt lgkmcnt(7)
    v_mfma_f32_32x32x16_bf16 v[24:39], v[116:119], a[100:103], v[24:39]
    ds_read_b128 a[108:111], v13 offset:0
    ds_read_b64_tr_b16 v[116:117], v17 offset:6144
    ds_read_b64_tr_b16 v[118:119], v17 offset:6656
    v_mfma_f32_32x32x16_bf16 v[40:55], v[120:123], a[100:103], v[40:55]
    ds_read_b64_tr_b16 v[120:121], v18 offset:6144
    ds_read_b64_tr_b16 v[122:123], v18 offset:6656
    v_mfma_f32_32x32x16_bf16 v[56:71], v[124:127], a[100:103], v[56:71]
    ds_read_b64_tr_b16 v[124:125], v19 offset:6144
    ds_read_b64_tr_b16 v[126:127], v19 offset:6656
    s_waitcnt vmcnt(4)
    s_barrier
    s_waitcnt lgkmcnt(7)
    v_mfma_f32_32x32x16_bf16 v[24:39], v[104:107], a[104:107], v[24:39]
    ds_read_b128 a[112:115], v10 offset:40960
    ds_read_b64_tr_b16 v[104:105], v17 offset:40960
    ds_read_b64_tr_b16 v[106:107], v17 offset:41472
    s_mov_b64 exec, s[10:11]
    global_load_dword v0, v[2:3], off
    s_mov_b64 exec, -1
    v_add_co_u32 v2, vcc, v15, v2
    s_nop 1
    v_addc_co_u32 v3, vcc, 0, v3, vcc
    s_lshr_b32 s99, s2, 5
    s_lshl_b32 s99, s99, 13
    s_lshl_b32 s100, s27, 16
    s_add_u32 s99, s99, s100
    v_lshl_add_u32 v9, v1, 7, s99
    v_mov_b32 v3, s19
    v_add_co_u32 v2, vcc, s18, v9
    s_nop 1
    v_addc_co_u32 v3, vcc, 0, v3, vcc
    s_mov_b64 exec, s[10:11]
    global_load_dword v0, v[2:3], off
    s_mov_b64 exec, -1
    v_add_co_u32 v2, vcc, v15, v2
    s_nop 1
    v_addc_co_u32 v3, vcc, 0, v3, vcc
    v_mfma_f32_32x32x16_bf16 v[40:55], v[108:111], a[104:107], v[40:55]
    ds_read_b64_tr_b16 v[108:109], v18 offset:40960
    ds_read_b64_tr_b16 v[110:111], v18 offset:41472
    v_mfma_f32_32x32x16_bf16 v[56:71], v[112:115], a[104:107], v[56:71]
    ds_read_b64_tr_b16 v[112:113], v19 offset:40960
    ds_read_b64_tr_b16 v[114:115], v19 offset:41472
    s_waitcnt lgkmcnt(7)
    v_mfma_f32_32x32x16_bf16 v[24:39], v[116:119], a[108:111], v[24:39]
    ds_read_b128 a[116:119], v11 offset:40960
    ds_read_b64_tr_b16 v[116:117], v17 offset:43008
    ds_read_b64_tr_b16 v[118:119], v17 offset:43520
    v_mfma_f32_32x32x16_bf16 v[40:55], v[120:123], a[108:111], v[40:55]
    ds_read_b64_tr_b16 v[120:121], v18 offset:43008
    ds_read_b64_tr_b16 v[122:123], v18 offset:43520
    v_mfma_f32_32x32x16_bf16 v[56:71], v[124:127], a[108:111], v[56:71]
    ds_read_b64_tr_b16 v[124:125], v19 offset:43008
    ds_read_b64_tr_b16 v[126:127], v19 offset:43520
    s_waitcnt lgkmcnt(7)
    v_mfma_f32_32x32x16_bf16 v[24:39], v[104:107], a[112:115], v[24:39]
    ds_read_b128 a[120:123], v12 offset:40960
    ds_read_b64_tr_b16 v[104:105], v17 offset:45056
    ds_read_b64_tr_b16 v[106:107], v17 offset:45568
    v_mfma_f32_32x32x16_bf16 v[40:55], v[108:111], a[112:115], v[40:55]
    ds_read_b64_tr_b16 v[108:109], v18 offset:45056
    ds_read_b64_tr_b16 v[110:111], v18 offset:45568
    v_mfma_f32_32x32x16_bf16 v[56:71], v[112:115], a[112:115], v[56:71]
    ds_read_b64_tr_b16 v[112:113], v19 offset:45056
    ds_read_b64_tr_b16 v[114:115], v19 offset:45568
    s_waitcnt lgkmcnt(7)
    v_mfma_f32_32x32x16_bf16 v[24:39], v[116:119], a[116:119], v[24:39]
    ds_read_b128 a[124:127], v13 offset:40960
    ds_read_b64_tr_b16 v[116:117], v17 offset:47104
    ds_read_b64_tr_b16 v[118:119], v17 offset:47616
    v_mfma_f32_32x32x16_bf16 v[40:55], v[120:123], a[116:119], v[40:55]
    ds_read_b64_tr_b16 v[120:121], v18 offset:47104
    ds_read_b64_tr_b16 v[122:123], v18 offset:47616
    v_mfma_f32_32x32x16_bf16 v[56:71], v[124:127], a[116:119], v[56:71]
    ds_read_b64_tr_b16 v[124:125], v19 offset:47104
    ds_read_b64_tr_b16 v[126:127], v19 offset:47616
    s_barrier
    s_waitcnt lgkmcnt(7)
    v_mfma_f32_32x32x16_bf16 v[24:39], v[104:107], a[120:123], v[24:39]
    s_lshr_b32 s99, s2, 5
    s_lshl_b32 s99, s99, 13
    s_lshl_b32 s100, s27, 16
    s_add_u32 s99, s99, s100
    v_lshl_add_u32 v9, v1, 7, s99
    v_mov_b32 v3, s21
    v_add_co_u32 v2, vcc, s20, v9
    s_nop 1
    v_addc_co_u32 v3, vcc, 0, v3, vcc
    s_mov_b64 exec, s[10:11]
    global_load_dword v0, v[2:3], off
    s_mov_b64 exec, -1
    v_add_co_u32 v2, vcc, v15, v2
    s_nop 1
    v_addc_co_u32 v3, vcc, 0, v3, vcc
    v_mfma_f32_32x32x16_bf16 v[40:55], v[108:111], a[120:123], v[40:55]
    ds_read_b64_tr_b16 v[104:105], v16 offset:32
    ds_read_b64_tr_b16 v[106:107], v16 offset:416
    v_mfma_f32_32x32x16_bf16 v[56:71], v[112:115], a[120:123], v[56:71]
    ds_read_b64_tr_b16 v[108:109], v16 offset:64
    ds_read_b64_tr_b16 v[110:111], v16 offset:448
    s_waitcnt lgkmcnt(4)
    v_mfma_f32_32x32x16_bf16 v[24:39], v[116:119], a[124:127], v[24:39]
    v_mfma_f32_32x32x16_bf16 v[40:55], v[120:123], a[124:127], v[40:55]
    ds_read_b64_tr_b16 v[116:117], v16 offset:1568
    ds_read_b64_tr_b16 v[118:119], v16 offset:1952
    v_mfma_f32_32x32x16_bf16 v[56:71], v[124:127], a[124:127], v[56:71]
    ds_read_b64_tr_b16 v[120:121], v16 offset:1600
    ds_read_b64_tr_b16 v[122:123], v16 offset:1984
    s_waitcnt lgkmcnt(4)
    v_mfma_f32_32x32x16_bf16 v[72:87], v[104:107], a[0:3], 0
    ds_read_b64_tr_b16 v[104:105], v16 offset:3104
    ds_read_b64_tr_b16 v[106:107], v16 offset:3488
    v_mfma_f32_32x32x16_bf16 v[88:103], v[108:111], a[0:3], 0
    ds_read_b64_tr_b16 v[108:109], v16 offset:3136
    ds_read_b64_tr_b16 v[110:111], v16 offset:3520
    s_waitcnt lgkmcnt(4)
    v_mfma_f32_32x32x16_bf16 v[72:87], v[116:119], a[4:7], v[72:87]
    ds_read_b64_tr_b16 v[116:117], v16 offset:4640
    ds_read_b64_tr_b16 v[118:119], v16 offset:5024
    v_mfma_f32_32x32x16_bf16 v[88:103], v[120:123], a[4:7], v[88:103]
    ds_read_b64_tr_b16 v[120:121], v16 offset:4672
    ds_read_b64_tr_b16 v[122:123], v16 offset:5056
    s_waitcnt lgkmcnt(4)
    v_mfma_f32_32x32x16_bf16 v[72:87], v[104:107], a[8:11], v[72:87]
    ds_read_b64_tr_b16 v[104:105], v16 offset:6176
    ds_read_b64_tr_b16 v[106:107], v16 offset:6560
    v_pk_mul_f32 v[24:25], v[24:25], s[92:93] op_sel_hi:[1,0]
    v_pk_mul_f32 v[26:27], v[26:27], s[92:93] op_sel_hi:[1,0]
    v_pk_mul_f32 v[28:29], v[28:29], s[92:93] op_sel_hi:[1,0]
    v_pk_mul_f32 v[30:31], v[30:31], s[92:93] op_sel_hi:[1,0]
    v_exp_f32 v24, v24
    v_exp_f32 v25, v25
    v_exp_f32 v26, v26
    v_exp_f32 v27, v27
    v_mfma_f32_32x32x16_bf16 v[88:103], v[108:111], a[8:11], v[88:103]
    ds_read_b64_tr_b16 v[108:109], v16 offset:6208
    ds_read_b64_tr_b16 v[110:111], v16 offset:6592
    v_exp_f32 v28, v28
    v_exp_f32 v29, v29
    v_exp_f32 v30, v30
    v_exp_f32 v31, v31
    v_pk_add_f32 v[24:25], v[24:25], 1.0 op_sel_hi:[1,0]
    v_pk_add_f32 v[26:27], v[26:27], 1.0 op_sel_hi:[1,0]
    v_pk_add_f32 v[28:29], v[28:29], 1.0 op_sel_hi:[1,0]
    v_pk_add_f32 v[30:31], v[30:31], 1.0 op_sel_hi:[1,0]
    s_waitcnt lgkmcnt(4)
    v_mfma_f32_32x32x16_bf16 v[72:87], v[116:119], a[12:15], v[72:87]
    ds_read_b64_tr_b16 v[116:117], v16 offset:7712
    ds_read_b64_tr_b16 v[118:119], v16 offset:8096
    v_rcp_f32 v24, v24
    v_rcp_f32 v25, v25
    v_rcp_f32 v26, v26
    v_rcp_f32 v27, v27
    v_rcp_f32 v28, v28
    v_rcp_f32 v29, v29
    v_rcp_f32 v30, v30
    v_rcp_f32 v31, v31
    v_mfma_f32_32x32x16_bf16 v[88:103], v[120:123], a[12:15], v[88:103]
    ds_read_b64_tr_b16 v[120:121], v16 offset:7744
    ds_read_b64_tr_b16 v[122:123], v16 offset:8128
    v_pk_mul_f32 v[24:25], v[24:25], v[32:33]
    v_pk_mul_f32 v[26:27], v[26:27], v[34:35]
    v_pk_mul_f32 v[28:29], v[28:29], v[36:37]
    v_pk_mul_f32 v[30:31], v[30:31], v[38:39]
    v_cvt_pk_bf16_f32 v32, v24, v25
    v_cvt_pk_bf16_f32 v33, v26, v27
    v_cvt_pk_bf16_f32 v34, v28, v29
    v_cvt_pk_bf16_f32 v35, v30, v31
    s_waitcnt vmcnt(4)
    s_mov_b32 s93, 0x40000
K1_TAGCHK7:
    v_readfirstlane_b32 s12, v20
    v_readfirstlane_b32 s13, v21
    s_sub_u32 s93, s93, 1
    s_cmp_eq_u32 s93, 0
    s_cbranch_scc1 K1_TAGOK8
    s_cmp_lg_u32 s12, 0
    s_cbranch_scc1 K1_TAGOK8
    s_sleep 1
    buffer_load_dwordx2 v[20:21], off, s[72:75], 0 sc1
    s_waitcnt vmcnt(0)
    s_branch K1_TAGCHK7
K1_TAGOK8:
    s_waitcnt lgkmcnt(4)
    v_mfma_f32_32x32x16_bf16 v[72:87], v[104:107], a[16:19], v[72:87]
    ds_read_b64_tr_b16 v[104:105], v16 offset:9248
    ds_read_b64_tr_b16 v[106:107], v16 offset:9632
    s_add_u32 s93, s84, 2048
    buffer_store_dwordx4 v[32:35], v14, s[64:67], s93 offen sc1
    v_pk_mul_f32 v[40:41], v[40:41], s[92:93] op_sel_hi:[1,0]
    v_pk_mul_f32 v[42:43], v[42:43], s[92:93] op_sel_hi:[1,0]
    v_pk_mul_f32 v[44:45], v[44:45], s[92:93] op_sel_hi:[1,0]
    v_pk_mul_f32 v[46:47], v[46:47], s[92:93] op_sel_hi:[1,0]
    v_exp_f32 v40, v40
    v_exp_f32 v41, v41
    v_exp_f32 v42, v42
    v_mfma_f32_32x32x16_bf16 v[88:103], v[108:111], a[16:19], v[88:103]
    ds_read_b64_tr_b16 v[108:109], v16 offset:9280
    ds_read_b64_tr_b16 v[110:111], v16 offset:9664
    v_exp_f32 v43, v43
    v_exp_f32 v44, v44
    v_exp_f32 v45, v45
    v_exp_f32 v46, v46
    v_exp_f32 v47, v47
    v_pk_add_f32 v[40:41], v[40:41], 1.0 op_sel_hi:[1,0]
    v_pk_add_f32 v[42:43], v[42:43], 1.0 op_sel_hi:[1,0]
    v_pk_add_f32 v[44:45], v[44:45], 1.0 op_sel_hi:[1,0]
    s_waitcnt lgkmcnt(4)
    v_mfma_f32_32x32x16_bf16 v[72:87], v[116:119], a[20:23], v[72:87]
    ds_read_b64_tr_b16 v[116:117], v16 offset:10784
    ds_read_b64_tr_b16 v[118:119], v16 offset:11168
    v_pk_add_f32 v[46:47], v[46:47], 1.0 op_sel_hi:[1,0]
    v_rcp_f32 v40, v40
    v_rcp_f32 v41, v41
    v_rcp_f32 v42, v42
    v_rcp_f32 v43, v43
    v_rcp_f32 v44, v44
    v_rcp_f32 v45, v45
    v_rcp_f32 v46, v46
    v_mfma_f32_32x32x16_bf16 v[88:103], v[120:123], a[20:23], v[88:103]
    ds_read_b64_tr_b16 v[120:121], v16 offset:10816
    ds_read_b64_tr_b16 v[122:123], v16 offset:11200
    v_rcp_f32 v47, v47
    v_pk_mul_f32 v[40:41], v[40:41], v[48:49]
    v_pk_mul_f32 v[42:43], v[42:43], v[50:51]
    v_pk_mul_f32 v[44:45], v[44:45], v[52:53]
    v_pk_mul_f32 v[46:47], v[46:47], v[54:55]
    v_cvt_pk_bf16_f32 v48, v40, v41
    v_cvt_pk_bf16_f32 v49, v42, v43
    v_cvt_pk_bf16_f32 v50, v44, v45
    s_barrier
    s_waitcnt lgkmcnt(4)
    v_mfma_f32_32x32x16_bf16 v[72:87], v[104:107], a[24:27], v[72:87]
    ds_read_b64_tr_b16 v[104:105], v16 offset:40992
    ds_read_b64_tr_b16 v[106:107], v16 offset:41376
    v_cvt_pk_bf16_f32 v51, v46, v47
    s_add_u32 s93, s84, 4096
    buffer_store_dwordx4 v[48:51], v14, s[64:67], s93 offen sc1
    v_pk_mul_f32 v[56:57], v[56:57], s[92:93] op_sel_hi:[1,0]
    v_pk_mul_f32 v[58:59], v[58:59], s[92:93] op_sel_hi:[1,0]
    v_pk_mul_f32 v[60:61], v[60:61], s[92:93] op_sel_hi:[1,0]
    v_pk_mul_f32 v[62:63], v[62:63], s[92:93] op_sel_hi:[1,0]
    v_exp_f32 v56, v56
    v_exp_f32 v57, v57
    v_mfma_f32_32x32x16_bf16 v[88:103], v[108:111], a[24:27], v[88:103]
    ds_read_b64_tr_b16 v[108:109], v16 offset:41024
    ds_read_b64_tr_b16 v[110:111], v16 offset:41408
    v_exp_f32 v58, v58
    v_exp_f32 v59, v59
    v_exp_f32 v60, v60
    v_exp_f32 v61, v61
    v_exp_f32 v62, v62
    v_exp_f32 v63, v63
    v_pk_add_f32 v[56:57], v[56:57], 1.0 op_sel_hi:[1,0]
    v_pk_add_f32 v[58:59], v[58:59], 1.0 op_sel_hi:[1,0]
    s_waitcnt lgkmcnt(4)
    v_mfma_f32_32x32x16_bf16 v[72:87], v[116:119], a[28:31], v[72:87]
    ds_read_b64_tr_b16 v[116:117], v16 offset:42528
    ds_read_b64_tr_b16 v[118:119], v16 offset:42912
    v_pk_add_f32 v[60:61], v[60:61], 1.0 op_sel_hi:[1,0]
    v_pk_add_f32 v[62:63], v[62:63], 1.0 op_sel_hi:[1,0]
    v_rcp_f32 v56, v56
    v_rcp_f32 v57, v57
    v_rcp_f32 v58, v58
    v_rcp_f32 v59, v59
    v_rcp_f32 v60, v60
    v_rcp_f32 v61, v61
    v_mfma_f32_32x32x16_bf16 v[88:103], v[120:123], a[28:31], v[88:103]
    ds_read_b64_tr_b16 v[120:121], v16 offset:42560
    ds_read_b64_tr_b16 v[122:123], v16 offset:42944
    v_rcp_f32 v62, v62
    v_rcp_f32 v63, v63
    v_pk_mul_f32 v[56:57], v[56:57], v[64:65]
    v_pk_mul_f32 v[58:59], v[58:59], v[66:67]
    v_pk_mul_f32 v[60:61], v[60:61], v[68:69]
    v_pk_mul_f32 v[62:63], v[62:63], v[70:71]
    v_cvt_pk_bf16_f32 v64, v56, v57
    v_cvt_pk_bf16_f32 v65, v58, v59
    s_waitcnt lgkmcnt(4)
    v_mfma_f32_32x32x16_bf16 v[72:87], v[104:107], a[32:35], v[72:87]
    ds_read_b64_tr_b16 v[104:105], v16 offset:44064
    ds_read_b64_tr_b16 v[106:107], v16 offset:44448
    v_cvt_pk_bf16_f32 v66, v60, v61
    v_cvt_pk_bf16_f32 v67, v62, v63
    s_add_u32 s93, s84, 6144
    buffer_store_dwordx4 v[64:67], v14, s[64:67], s93 offen sc1
    v_mfma_f32_32x32x16_bf16 v[88:103], v[108:111], a[32:35], v[88:103]
    ds_read_b64_tr_b16 v[108:109], v16 offset:44096
    ds_read_b64_tr_b16 v[110:111], v16 offset:44480
    s_waitcnt lgkmcnt(4)
    v_mfma_f32_32x32x16_bf16 v[72:87], v[116:119], a[36:39], v[72:87]
    ds_read_b64_tr_b16 v[116:117], v16 offset:45600
    ds_read_b64_tr_b16 v[118:119], v16 offset:45984
    v_mfma_f32_32x32x16_bf16 v[88:103], v[120:123], a[36:39], v[88:103]
    ds_read_b64_tr_b16 v[120:121], v16 offset:45632
    ds_read_b64_tr_b16 v[122:123], v16 offset:46016
    s_waitcnt lgkmcnt(4)
    v_mfma_f32_32x32x16_bf16 v[72:87], v[104:107], a[40:43], v[72:87]
    ds_read_b64_tr_b16 v[104:105], v16 offset:47136
    ds_read_b64_tr_b16 v[106:107], v16 offset:47520
    v_mfma_f32_32x32x16_bf16 v[88:103], v[108:111], a[40:43], v[88:103]
    ds_read_b64_tr_b16 v[108:109], v16 offset:47168
    ds_read_b64_tr_b16 v[110:111], v16 offset:47552
    s_mul_i32 s100, s26, 360448
    s_add_u32 s52, s40, s100
    s_addc_u32 s53, s41, 0
    s_mov_b32 s54, 0x58000
    s_mov_b32 s56, s36
    s_mov_b32 s57, s37
    s_mov_b32 s58, 0x400000
    s_mov_b32 s59, 0x00020000
    s_mov_b32 s48, s32
    s_mov_b32 s49, s33
    s_mov_b32 s50, 0x1c0000
    s_mov_b32 s51, 0x00020000
    v_lshrrev_b32 v18, 3, v1
    v_and_b32 v19, 7, v1
    v_lshlrev_b32 v17, 10, v18
    v_and_b32 v18, 2, v18
    v_lshlrev_b32 v18, 1, v18
    v_xor_b32 v19, v19, v18
    v_lshl_add_u32 v17, v19, 4, v17
    s_lshl_b32 s99, s27, 7
    v_add_u32 v17, s99, v17
    s_mul_i32 s4, s42, 40960
    s_add_u32 s4, s4, 24832
    v_lshrrev_b32 v18, 5, v1
    v_lshlrev_b32 v18, 9, v18
    v_bfe_u32 v19, v1, 2, 2
    v_lshl_add_u32 v18, v19, 7, v18
    v_bfe_u32 v19, v1, 3, 1
    v_lshl_add_u32 v18, v19, 6, v18
    v_bfe_u32 v19, v1, 4, 1
    v_lshl_add_u32 v18, v19, 5, v18
    v_and_b32 v19, 3, v1
    v_lshl_add_u32 v18, v19, 3, v18
    v_add_u32 v18, s4, v18
    v_xor_b32 v19, 64, v18
    s_lshl_b32 s22, s42, 15
    s_add_u32 s22, s22, 131072
    s_mul_i32 s23, s42, 24576
    s_add_u32 s23, s23, 262144
    s_lshl_b32 s3, s42, 18
    s_mul_i32 s87, s42, 196608
    s_add_u32 s87, s87, 1048576
    v_add_u32 v59, 7168, v17
    s_add_u32 m0, s4, 0
    s_add_u32 s85, s3, 196608
    buffer_load_dwordx4 v17, s[48:51], s85 offen lds
    buffer_load_dwordx4 v59, s[48:51], s85 offen offset:1024 lds
    s_waitcnt lgkmcnt(4)
    v_mfma_f32_32x32x16_bf16 v[72:87], v[116:119], a[44:47], v[72:87]
    ds_read_b64_tr_b16 v[116:117], v16 offset:48672
    ds_read_b64_tr_b16 v[118:119], v16 offset:49056
    v_mfma_f32_32x32x16_bf16 v[88:103], v[120:123], a[44:47], v[88:103]
    ds_read_b64_tr_b16 v[120:121], v16 offset:48704
    ds_read_b64_tr_b16 v[122:123], v16 offset:49088
    s_add_u32 m0, s4, 2048
    s_add_u32 s85, s3, 212992
    buffer_load_dwordx4 v17, s[48:51], s85 offen lds
    buffer_load_dwordx4 v59, s[48:51], s85 offen offset:1024 lds
    s_waitcnt lgkmcnt(4)
    v_mfma_f32_32x32x16_bf16 v[72:87], v[104:107], a[48:51], v[72:87]
    ds_read_b64_tr_b16 v[104:105], v16 offset:50208
    ds_read_b64_tr_b16 v[106:107], v16 offset:50592
    v_mfma_f32_32x32x16_bf16 v[88:103], v[108:111], a[48:51], v[88:103]
    ds_read_b64_tr_b16 v[108:109], v16 offset:50240
    ds_read_b64_tr_b16 v[110:111], v16 offset:50624
    s_add_u32 m0, s4, 4096
    s_add_u32 s85, s3, 229376
    buffer_load_dwordx4 v17, s[48:51], s85 offen lds
    buffer_load_dwordx4 v59, s[48:51], s85 offen offset:1024 lds
    s_waitcnt lgkmcnt(4)
    v_mfma_f32_32x32x16_bf16 v[72:87], v[116:119], a[52:55], v[72:87]
    ds_read_b64_tr_b16 v[116:117], v16 offset:51744
    ds_read_b64_tr_b16 v[118:119], v16 offset:52128
    v_mfma_f32_32x32x16_bf16 v[88:103], v[120:123], a[52:55], v[88:103]
    ds_read_b64_tr_b16 v[120:121], v16 offset:51776
    ds_read_b64_tr_b16 v[122:123], v16 offset:52160
    s_add_u32 m0, s4, 6144
    s_add_u32 s85, s3, 245760
    buffer_load_dwordx4 v17, s[48:51], s85 offen lds
    buffer_load_dwordx4 v59, s[48:51], s85 offen offset:1024 lds
    s_barrier
    s_waitcnt lgkmcnt(4)
    v_mfma_f32_32x32x16_bf16 v[72:87], v[104:107], a[56:59], v[72:87]
    v_add_u32 v16, 81920, v16
    ds_read_b64_tr_b16 v[104:105], v16 offset:32
    ds_read_b64_tr_b16 v[106:107], v16 offset:416
    v_mfma_f32_32x32x16_bf16 v[88:103], v[108:111], a[56:59], v[88:103]
    ds_read_b64_tr_b16 v[108:109], v16 offset:64
    ds_read_b64_tr_b16 v[110:111], v16 offset:448
    s_waitcnt lgkmcnt(4)
    v_mfma_f32_32x32x16_bf16 v[72:87], v[116:119], a[60:63], v[72:87]
    ds_read_b64_tr_b16 v[116:117], v16 offset:1568
    ds_read_b64_tr_b16 v[118:119], v16 offset:1952
    v_mfma_f32_32x32x16_bf16 v[88:103], v[120:123], a[60:63], v[88:103]
    ds_read_b64_tr_b16 v[120:121], v16 offset:1600
    ds_read_b64_tr_b16 v[122:123], v16 offset:1984
    s_waitcnt lgkmcnt(4)
    v_mfma_f32_32x32x16_bf16 v[72:87], v[104:107], a[64:67], v[72:87]
    ds_read_b64_tr_b16 v[104:105], v16 offset:3104
    ds_read_b64_tr_b16 v[106:107], v16 offset:3488
    v_mfma_f32_32x32x16_bf16 v[88:103], v[108:111], a[64:67], v[88:103]
    ds_read_b64_tr_b16 v[108:109], v16 offset:3136
    ds_read_b64_tr_b16 v[110:111], v16 offset:3520
    s_waitcnt lgkmcnt(4)
    v_mfma_f32_32x32x16_bf16 v[72:87], v[116:119], a[68:71], v[72:87]
    ds_read_b64_tr_b16 v[116:117], v16 offset:4640
    ds_read_b64_tr_b16 v[118:119], v16 offset:5024
    v_mfma_f32_32x32x16_bf16 v[88:103], v[120:123], a[68:71], v[88:103]
    ds_read_b64_tr_b16 v[120:121], v16 offset:4672
    ds_read_b64_tr_b16 v[122:123], v16 offset:5056
    s_waitcnt lgkmcnt(4)
    v_mfma_f32_32x32x16_bf16 v[72:87], v[104:107], a[72:75], v[72:87]
    ds_read_b64_tr_b16 v[104:105], v16 offset:6176
    ds_read_b64_tr_b16 v[106:107], v16 offset:6560
    v_mfma_f32_32x32x16_bf16 v[88:103], v[108:111], a[72:75], v[88:103]
    ds_read_b64_tr_b16 v[108:109], v16 offset:6208
    ds_read_b64_tr_b16 v[110:111], v16 offset:6592
    s_waitcnt lgkmcnt(4)
    v_mfma_f32_32x32x16_bf16 v[72:87], v[116:119], a[76:79], v[72:87]
    ds_read_b64_tr_b16 v[116:117], v16 offset:7712
    ds_read_b64_tr_b16 v[118:119], v16 offset:8096
    v_mfma_f32_32x32x16_bf16 v[88:103], v[120:123], a[76:79], v[88:103]
    ds_read_b64_tr_b16 v[120:121], v16 offset:7744
    ds_read_b64_tr_b16 v[122:123], v16 offset:8128
    s_waitcnt lgkmcnt(4)
    v_mfma_f32_32x32x16_bf16 v[72:87], v[104:107], a[80:83], v[72:87]
    ds_read_b64_tr_b16 v[104:105], v16 offset:9248
    ds_read_b64_tr_b16 v[106:107], v16 offset:9632
    v_mfma_f32_32x32x16_bf16 v[88:103], v[108:111], a[80:83], v[88:103]
    ds_read_b64_tr_b16 v[108:109], v16 offset:9280
    ds_read_b64_tr_b16 v[110:111], v16 offset:9664
    s_waitcnt vmcnt(6)
    ds_read_b64_tr_b16 a[0:1], v18 offset:0
    ds_read_b64_tr_b16 a[2:3], v18 offset:1024
    ds_read_b64_tr_b16 a[4:5], v19 offset:0
    ds_read_b64_tr_b16 a[6:7], v19 offset:1024
    s_add_u32 m0, s4, 8192
    s_add_u32 s85, s3, 0
    buffer_load_dwordx4 v17, s[48:51], s85 offen lds
    buffer_load_dwordx4 v59, s[48:51], s85 offen offset:1024 lds
    s_waitcnt lgkmcnt(8)
    v_mfma_f32_32x32x16_bf16 v[72:87], v[116:119], a[84:87], v[72:87]
    ds_read_b64_tr_b16 v[116:117], v16 offset:10784
    ds_read_b64_tr_b16 v[118:119], v16 offset:11168
    v_mfma_f32_32x32x16_bf16 v[88:103], v[120:123], a[84:87], v[88:103]
    ds_read_b64_tr_b16 v[120:121], v16 offset:10816
    ds_read_b64_tr_b16 v[122:123], v16 offset:11200
    s_waitcnt vmcnt(6)
    ds_read_b64_tr_b16 a[8:9], v18 offset:2048
    ds_read_b64_tr_b16 a[10:11], v18 offset:3072
    ds_read_b64_tr_b16 a[12:13], v19 offset:2048
    ds_read_b64_tr_b16 a[14:15], v19 offset:3072
    s_waitcnt lgkmcnt(8)
    s_add_u32 m0, s4, 0
    s_add_u32 s85, s3, 16384
    buffer_load_dwordx4 v17, s[48:51], s85 offen lds
    buffer_load_dwordx4 v59, s[48:51], s85 offen offset:1024 lds
    s_barrier
    s_cmp_eq_u32 s42, 0
    s_cbranch_scc0 K1_NOEF
    s_lshl_b32 s99, s5, 7
    s_lshl_b32 s100, s6, 3
    s_add_u32 s99, s99, s100
    s_add_u32 s99, s99, 0x1141000
    v_mov_b32 v20, s12
    v_mov_b32 v21, s13
    s_mov_b64 exec, 1
    buffer_store_dwordx2 v[20:21], off, s[64:67], s99 sc1
    s_mov_b64 exec, -1
K1_NOEF:
    v_mfma_f32_32x32x16_bf16 v[72:87], v[104:107], a[88:91], v[72:87]
    ds_read_b64_tr_b16 v[104:105], v16 offset:40992
    ds_read_b64_tr_b16 v[106:107], v16 offset:41376
    v_mfma_f32_32x32x16_bf16 v[88:103], v[108:111], a[88:91], v[88:103]
    ds_read_b64_tr_b16 v[108:109], v16 offset:41024
    ds_read_b64_tr_b16 v[110:111], v16 offset:41408
    s_waitcnt vmcnt(6)
    ds_read_b64_tr_b16 a[16:17], v18 offset:4096
    ds_read_b64_tr_b16 a[18:19], v18 offset:5120
    ds_read_b64_tr_b16 a[20:21], v19 offset:4096
    ds_read_b64_tr_b16 a[22:23], v19 offset:5120
    s_waitcnt lgkmcnt(8)
    s_add_u32 m0, s4, 2048
    s_add_u32 s85, s3, 32768
    buffer_load_dwordx4 v17, s[48:51], s85 offen lds
    buffer_load_dwordx4 v59, s[48:51], s85 offen offset:1024 lds
    v_mfma_f32_32x32x16_bf16 v[72:87], v[116:119], a[92:95], v[72:87]
    ds_read_b64_tr_b16 v[116:117], v16 offset:42528
    ds_read_b64_tr_b16 v[118:119], v16 offset:42912
    v_mfma_f32_32x32x16_bf16 v[88:103], v[120:123], a[92:95], v[88:103]
    ds_read_b64_tr_b16 v[120:121], v16 offset:42560
    ds_read_b64_tr_b16 v[122:123], v16 offset:42944
    s_waitcnt vmcnt(6)
    ds_read_b64_tr_b16 a[24:25], v18 offset:6144
    ds_read_b64_tr_b16 a[26:27], v18 offset:7168
    ds_read_b64_tr_b16 a[28:29], v19 offset:6144
    ds_read_b64_tr_b16 a[30:31], v19 offset:7168
    s_waitcnt lgkmcnt(8)
    s_add_u32 m0, s4, 4096
    s_add_u32 s85, s3, 49152
    buffer_load_dwordx4 v17, s[48:51], s85 offen lds
    buffer_load_dwordx4 v59, s[48:51], s85 offen offset:1024 lds
    v_mfma_f32_32x32x16_bf16 v[72:87], v[104:107], a[96:99], v[72:87]
    ds_read_b64_tr_b16 v[104:105], v16 offset:44064
    ds_read_b64_tr_b16 v[106:107], v16 offset:44448
    v_mfma_f32_32x32x16_bf16 v[88:103], v[108:111], a[96:99], v[88:103]
    ds_read_b64_tr_b16 v[108:109], v16 offset:44096
    ds_read_b64_tr_b16 v[110:111], v16 offset:44480
    s_waitcnt vmcnt(6)
    ds_read_b64_tr_b16 a[32:33], v18 offset:8192
    ds_read_b64_tr_b16 a[34:35], v18 offset:9216
    ds_read_b64_tr_b16 a[36:37], v19 offset:8192
    ds_read_b64_tr_b16 a[38:39], v19 offset:9216
    s_waitcnt lgkmcnt(8)
    s_add_u32 m0, s4, 6144
    s_add_u32 s85, s3, 65536
    buffer_load_dwordx4 v17, s[48:51], s85 offen lds
    buffer_load_dwordx4 v59, s[48:51], s85 offen offset:1024 lds
    v_mfma_f32_32x32x16_bf16 v[72:87], v[116:119], a[100:103], v[72:87]
    ds_read_b64_tr_b16 v[116:117], v16 offset:45600
    ds_read_b64_tr_b16 v[118:119], v16 offset:45984
    v_mfma_f32_32x32x16_bf16 v[88:103], v[120:123], a[100:103], v[88:103]
    ds_read_b64_tr_b16 v[120:121], v16 offset:45632
    ds_read_b64_tr_b16 v[122:123], v16 offset:46016
    s_waitcnt vmcnt(6)
    ds_read_b64_tr_b16 a[40:41], v18 offset:0
    ds_read_b64_tr_b16 a[42:43], v18 offset:1024
    ds_read_b64_tr_b16 a[44:45], v19 offset:0
    ds_read_b64_tr_b16 a[46:47], v19 offset:1024
    s_waitcnt lgkmcnt(8)
    s_add_u32 m0, s4, 8192
    s_add_u32 s85, s3, 81920
    buffer_load_dwordx4 v17, s[48:51], s85 offen lds
    buffer_load_dwordx4 v59, s[48:51], s85 offen offset:1024 lds
    v_mfma_f32_32x32x16_bf16 v[72:87], v[104:107], a[104:107], v[72:87]
    ds_read_b64_tr_b16 v[104:105], v16 offset:47136
    ds_read_b64_tr_b16 v[106:107], v16 offset:47520
    v_mfma_f32_32x32x16_bf16 v[88:103], v[108:111], a[104:107], v[88:103]
    ds_read_b64_tr_b16 v[108:109], v16 offset:47168
    ds_read_b64_tr_b16 v[110:111], v16 offset:47552
    s_waitcnt vmcnt(6)
    ds_read_b64_tr_b16 a[48:49], v18 offset:2048
    ds_read_b64_tr_b16 a[50:51], v18 offset:3072
    ds_read_b64_tr_b16 a[52:53], v19 offset:2048
    ds_read_b64_tr_b16 a[54:55], v19 offset:3072
    s_waitcnt lgkmcnt(8)
    s_add_u32 m0, s4, 0
    s_add_u32 s85, s3, 98304
    buffer_load_dwordx4 v17, s[48:51], s85 offen lds
    buffer_load_dwordx4 v59, s[48:51], s85 offen offset:1024 lds
    v_mfma_f32_32x32x16_bf16 v[72:87], v[116:119], a[108:111], v[72:87]
    ds_read_b64_tr_b16 v[116:117], v16 offset:48672
    ds_read_b64_tr_b16 v[118:119], v16 offset:49056
    v_mfma_f32_32x32x16_bf16 v[88:103], v[120:123], a[108:111], v[88:103]
    ds_read_b64_tr_b16 v[120:121], v16 offset:48704
    ds_read_b64_tr_b16 v[122:123], v16 offset:49088
    s_waitcnt vmcnt(6)
    ds_read_b64_tr_b16 a[56:57], v18 offset:4096
    ds_read_b64_tr_b16 a[58:59], v18 offset:5120
    ds_read_b64_tr_b16 a[60:61], v19 offset:4096
    ds_read_b64_tr_b16 a[62:63], v19 offset:5120
    s_waitcnt lgkmcnt(8)
    s_add_u32 m0, s4, 2048
    s_add_u32 s85, s3, 114688
    buffer_load_dwordx4 v17, s[48:51], s85 offen lds
    buffer_load_dwordx4 v59, s[48:51], s85 offen offset:1024 lds
    v_mfma_f32_32x32x16_bf16 v[72:87], v[104:107], a[112:115], v[72:87]
    ds_read_b64_tr_b16 v[104:105], v16 offset:50208
    ds_read_b64_tr_b16 v[106:107], v16 offset:50592
    v_mfma_f32_32x32x16_bf16 v[88:103], v[108:111], a[112:115], v[88:103]
    ds_read_b64_tr_b16 v[108:109], v16 offset:50240
    ds_read_b64_tr_b16 v[110:111], v16 offset:50624
    s_waitcnt vmcnt(6)
    ds_read_b64_tr_b16 a[64:65], v18 offset:6144
    ds_read_b64_tr_b16 a[66:67], v18 offset:7168
    ds_read_b64_tr_b16 a[68:69], v19 offset:6144
    ds_read_b64_tr_b16 a[70:71], v19 offset:7168
    s_waitcnt lgkmcnt(8)
    s_add_u32 m0, s4, 4096
    s_add_u32 s85, s3, 131072
    buffer_load_dwordx4 v17, s[48:51], s85 offen lds
    buffer_load_dwordx4 v59, s[48:51], s85 offen offset:1024 lds
    v_mfma_f32_32x32x16_bf16 v[72:87], v[116:119], a[116:119], v[72:87]
    ds_read_b64_tr_b16 v[116:117], v16 offset:51744
    ds_read_b64_tr_b16 v[118:119], v16 offset:52128
    v_mfma_f32_32x32x16_bf16 v[88:103], v[120:123], a[116:119], v[88:103]
    ds_read_b64_tr_b16 v[120:121], v16 offset:51776
    ds_read_b64_tr_b16 v[122:123], v16 offset:52160
    s_waitcnt vmcnt(6)
    ds_read_b64_tr_b16 a[72:73], v18 offset:8192
    ds_read_b64_tr_b16 a[74:75], v18 offset:9216
    ds_read_b64_tr_b16 a[76:77], v19 offset:8192
    ds_read_b64_tr_b16 a[78:79], v19 offset:9216
    s_waitcnt lgkmcnt(8)
    s_add_u32 m0, s4, 6144
    s_add_u32 s85, s3, 147456
    buffer_load_dwordx4 v17, s[48:51], s85 offen lds
    buffer_load_dwordx4 v59, s[48:51], s85 offen offset:1024 lds
    v_mfma_f32_32x32x16_bf16 v[72:87], v[104:107], a[120:123], v[72:87]
    v_mfma_f32_32x32x16_bf16 v[88:103], v[108:111], a[120:123], v[88:103]
    s_waitcnt vmcnt(6)
    ds_read_b64_tr_b16 a[80:81], v18 offset:0
    ds_read_b64_tr_b16 a[82:83], v18 offset:1024
    ds_read_b64_tr_b16 a[84:85], v19 offset:0
    ds_read_b64_tr_b16 a[86:87], v19 offset:1024
    s_waitcnt lgkmcnt(4)
    s_add_u32 m0, s4, 8192
    s_add_u32 s85, s3, 163840
    buffer_load_dwordx4 v17, s[48:51], s85 offen lds
    buffer_load_dwordx4 v59, s[48:51], s85 offen offset:1024 lds
    v_mfma_f32_32x32x16_bf16 v[72:87], v[116:119], a[124:127], v[72:87]
    v_mfma_f32_32x32x16_bf16 v[88:103], v[120:123], a[124:127], v[88:103]
    s_waitcnt vmcnt(6)
    ds_read_b64_tr_b16 a[88:89], v18 offset:2048
    ds_read_b64_tr_b16 a[90:91], v18 offset:3072
    ds_read_b64_tr_b16 a[92:93], v19 offset:2048
    ds_read_b64_tr_b16 a[94:95], v19 offset:3072
    s_waitcnt lgkmcnt(4)
    s_add_u32 m0, s4, 0
    s_add_u32 s85, s3, 180224
    buffer_load_dwordx4 v17, s[48:51], s85 offen lds
    buffer_load_dwordx4 v59, s[48:51], s85 offen offset:1024 lds
    s_lshr_b32 s99, s26, 1
    s_lshl_b32 s99, s99, 7
    s_add_u32 s99, s99, 0x1141000
    v_and_b32 v23, 15, v1
    v_lshl_add_u32 v22, v23, 3, s99
    buffer_load_dwordx2 v[20:21], v22, s[64:67], 0 offen sc1
    s_waitcnt vmcnt(7)
    ds_read_b64_tr_b16 a[96:97], v18 offset:4096
    ds_read_b64_tr_b16 a[98:99], v18 offset:5120
    ds_read_b64_tr_b16 a[100:101], v19 offset:4096
    ds_read_b64_tr_b16 a[102:103], v19 offset:5120
    s_waitcnt lgkmcnt(4)
    s_add_u32 m0, s4, 2048
    s_add_u32 s85, s87, 0
    buffer_load_dwordx4 v17, s[48:51], s85 offen lds
    buffer_load_dwordx4 v59, s[48:51], s85 offen offset:1024 lds
    s_nop 7
    s_nop 3
    v_pk_mul_f32 v[72:73], v[72:73], s[92:93] op_sel_hi:[1,0]
    v_pk_mul_f32 v[74:75], v[74:75], s[92:93] op_sel_hi:[1,0]
    v_pk_mul_f32 v[76:77], v[76:77], s[92:93] op_sel_hi:[1,0]
    v_pk_mul_f32 v[78:79], v[78:79], s[92:93] op_sel_hi:[1,0]
    v_exp_f32 v72, v72
    v_exp_f32 v73, v73
    v_exp_f32 v74, v74
    v_exp_f32 v75, v75
    v_exp_f32 v76, v76
    v_exp_f32 v77, v77
    v_exp_f32 v78, v78
    v_exp_f32 v79, v79
    s_waitcnt vmcnt(7)
    ds_read_b64_tr_b16 a[104:105], v18 offset:6144
    ds_read_b64_tr_b16 a[106:107], v18 offset:7168
    ds_read_b64_tr_b16 a[108:109], v19 offset:6144
    ds_read_b64_tr_b16 a[110:111], v19 offset:7168
    s_waitcnt lgkmcnt(4)
    s_add_u32 m0, s4, 4096
    s_add_u32 s85, s87, 16384
    buffer_load_dwordx4 v17, s[48:51], s85 offen lds
    buffer_load_dwordx4 v59, s[48:51], s85 offen offset:1024 lds
    v_pk_add_f32 v[72:73], v[72:73], 1.0 op_sel_hi:[1,0]
    v_pk_add_f32 v[74:75], v[74:75], 1.0 op_sel_hi:[1,0]
    v_pk_add_f32 v[76:77], v[76:77], 1.0 op_sel_hi:[1,0]
    v_pk_add_f32 v[78:79], v[78:79], 1.0 op_sel_hi:[1,0]
    v_rcp_f32 v72, v72
    v_rcp_f32 v73, v73
    v_rcp_f32 v74, v74
    v_rcp_f32 v75, v75
    v_rcp_f32 v76, v76
    v_rcp_f32 v77, v77
    v_rcp_f32 v78, v78
    v_rcp_f32 v79, v79
    s_waitcnt vmcnt(7)
    ds_read_b64_tr_b16 a[112:113], v18 offset:8192
    ds_read_b64_tr_b16 a[114:115], v18 offset:9216
    ds_read_b64_tr_b16 a[116:117], v19 offset:8192
    ds_read_b64_tr_b16 a[118:119], v19 offset:9216
    s_waitcnt lgkmcnt(4)
    s_add_u32 m0, s4, 6144
    s_add_u32 s85, s87, 32768
    buffer_load_dwordx4 v17, s[48:51], s85 offen lds
    buffer_load_dwordx4 v59, s[48:51], s85 offen offset:1024 lds
    v_pk_mul_f32 v[72:73], v[72:73], v[80:81]
    v_pk_mul_f32 v[74:75], v[74:75], v[82:83]
    v_pk_mul_f32 v[76:77], v[76:77], v[84:85]
    v_pk_mul_f32 v[78:79], v[78:79], v[86:87]
    v_cvt_pk_bf16_f32 v80, v72, v73
    v_cvt_pk_bf16_f32 v81, v74, v75
    v_cvt_pk_bf16_f32 v82, v76, v77
    v_cvt_pk_bf16_f32 v83, v78, v79
    s_add_u32 s93, s95, 2048
    buffer_store_dwordx4 v[80:83], v14, s[64:67], s93 offen sc1
    v_pk_mul_f32 v[88:89], v[88:89], s[92:93] op_sel_hi:[1,0]
    v_pk_mul_f32 v[90:91], v[90:91], s[92:93] op_sel_hi:[1,0]
    v_pk_mul_f32 v[92:93], v[92:93], s[92:93] op_sel_hi:[1,0]
    s_waitcnt vmcnt(8)
    ds_read_b64_tr_b16 a[120:121], v18 offset:0
    ds_read_b64_tr_b16 a[122:123], v18 offset:1024
    ds_read_b64_tr_b16 a[124:125], v19 offset:0
    ds_read_b64_tr_b16 a[126:127], v19 offset:1024
    s_waitcnt lgkmcnt(4)
    s_add_u32 m0, s4, 8192
    s_add_u32 s85, s87, 49152
    buffer_load_dwordx4 v17, s[48:51], s85 offen lds
    buffer_load_dwordx4 v59, s[48:51], s85 offen offset:1024 lds
    v_pk_mul_f32 v[94:95], v[94:95], s[92:93] op_sel_hi:[1,0]
    v_exp_f32 v88, v88
    v_exp_f32 v89, v89
    v_exp_f32 v90, v90
    v_exp_f32 v91, v91
    v_exp_f32 v92, v92
    v_exp_f32 v93, v93
    v_exp_f32 v94, v94
    v_exp_f32 v95, v95
    v_pk_add_f32 v[88:89], v[88:89], 1.0 op_sel_hi:[1,0]
    v_pk_add_f32 v[90:91], v[90:91], 1.0 op_sel_hi:[1,0]
    v_pk_add_f32 v[92:93], v[92:93], 1.0 op_sel_hi:[1,0]
    v_pk_add_f32 v[94:95], v[94:95], 1.0 op_sel_hi:[1,0]
    v_rcp_f32 v88, v88
    v_rcp_f32 v89, v89
    v_rcp_f32 v90, v90
    v_rcp_f32 v91, v91
    v_rcp_f32 v92, v92
    v_rcp_f32 v93, v93
    v_rcp_f32 v94, v94
    v_rcp_f32 v95, v95
    v_pk_mul_f32 v[88:89], v[88:89], v[96:97]
    v_pk_mul_f32 v[90:91], v[90:91], v[98:99]
    v_pk_mul_f32 v[92:93], v[92:93], v[100:101]
    v_pk_mul_f32 v[94:95], v[94:95], v[102:103]
    v_cvt_pk_bf16_f32 v96, v88, v89
    v_cvt_pk_bf16_f32 v97, v90, v91
    v_cvt_pk_bf16_f32 v98, v92, v93
    v_cvt_pk_bf16_f32 v99, v94, v95
    s_add_u32 s93, s95, 4096
    buffer_store_dwordx4 v[96:99], v14, s[64:67], s93 offen sc1
    v_bfe_u32 v68, v1, 2, 1
    v_lshlrev_b32 v13, 4, v68
    v_bfe_u32 v68, v1, 3, 2
    v_lshl_add_u32 v13, v68, 2, v13
    v_and_b32 v68, 3, v1
    v_add_u32 v13, v13, v68
    s_lshl_b32 s99, s26, 6
    s_lshr_b32 s100, s42, 1
    s_lshl_b32 s100, s100, 5
    s_add_u32 s99, s99, s100
    v_add_u32 v13, s99, v13
    s_lshl_b32 s99, s27, 6
    s_and_b32 s100, s42, 1
    s_lshl_b32 s100, s100, 5
    s_add_u32 s99, s99, s100
    s_lshl_b32 s100, s43, 4
    s_add_u32 s99, s99, s100
    v_lshrrev_b32 v68, 5, v1
    v_lshlrev_b32 v68, 2, v68
    v_add_u32 v68, s99, v68
    v_lshlrev_b32 v69, 1, v68
    v_lshl_add_u32 v68, v13, 10, v69
    v_lshlrev_b32 v12, 1, v68
    v_lshlrev_b32 v13, 3, v13
    s_mov_b32 s80, s24
    s_mov_b32 s81, s25
    s_mov_b32 s82, 0x400
    s_mov_b32 s83, 0x00020000
    buffer_load_dwordx2 v[2:3], v68, s[44:47], 0 offen offset:0
    buffer_load_dwordx2 v[6:7], v69, s[80:83], 0 offen offset:0
    buffer_load_dwordx2 v[4:5], v68, s[44:47], 0 offen offset:16
    buffer_load_dwordx2 v[8:9], v69, s[80:83], 0 offen offset:16
    s_mul_i32 s99, s42, 40960
    s_xor_b32 s100, s43, 1
    s_lshl_b32 s100, s100, 14
    s_add_u32 s99, s99, s100
    v_add_u32 v15, s99, v14
    s_waitcnt vmcnt(4)
    v_mov_b32 v60, 162048
    v_mov_b32 v61, 1
    s_mov_b64 exec, 1
    ds_add_rtn_u32 v61, v60, v61
    s_mov_b64 exec, -1
    s_lshl_b32 s99, s5, 7
    s_lshl_b32 s100, s6, 3
    s_add_u32 s99, s99, s100
    s_add_u32 s99, s99, 0x1141800
    s_waitcnt lgkmcnt(0)
    v_readfirstlane_b32 s100, v61
    s_cmp_eq_u32 s100, 7
    s_cbranch_scc0 K1_NOL9
    v_mov_b32 v60, s12
    v_mov_b32 v61, s13
    s_mov_b64 exec, 1
    buffer_store_dwordx2 v[60:61], off, s[64:67], s99 sc1
    s_mov_b64 exec, -1
K1_NOL9:
    s_mov_b32 s93, 0x40000
K1_FCHK10:
    v_cmp_ne_u64 s[0:1], v[20:21], s[12:13]
    s_sub_u32 s93, s93, 1
    s_cmp_eq_u32 s93, 0
    s_cbranch_scc1 K1_FOK11
    s_cmp_eq_u64 s[0:1], 0
    s_cbranch_scc1 K1_FOK11
    s_sleep 1
    buffer_load_dwordx2 v[20:21], v22, s[64:67], 0 offen sc1
    s_waitcnt vmcnt(0)
    s_branch K1_FCHK10
K1_FOK11:
    s_add_u32 s86, s22, 0
    buffer_load_dwordx4 v[24:27], v14, s[52:55], s86 offen offset:0 sc1
    buffer_load_dwordx4 v[28:31], v14, s[52:55], s86 offen offset:1024 sc1
    buffer_load_dwordx4 v[32:35], v14, s[52:55], s86 offen offset:2048 sc1
    buffer_load_dwordx4 v[36:39], v14, s[52:55], s86 offen offset:3072 sc1
    s_add_u32 s86, s22, 4096
    buffer_load_dwordx4 v[40:43], v14, s[52:55], s86 offen offset:0 sc1
    buffer_load_dwordx4 v[44:47], v14, s[52:55], s86 offen offset:1024 sc1
    s_waitcnt vmcnt(4)
    v_mfma_f32_32x32x16_bf16 v[64:79], a[32:35], v[24:27], 0
    v_lshlrev_b32 v0, 16, v2
    v_mfma_f32_32x32x16_bf16 v[80:95], a[36:39], v[24:27], 0
    v_and_b32 v2, 0xffff0000, v2
    v_lshlrev_b32 v10, 16, v6
    v_mfma_f32_32x32x16_bf16 v[96:111], a[32:35], v[28:31], 0
    v_and_b32 v6, 0xffff0000, v6
    v_mul_f32 v0, v0, v10
    v_mfma_f32_32x32x16_bf16 v[112:127], a[36:39], v[28:31], 0
    v_mul_f32 v2, v2, v6
    v_cvt_pk_bf16_f32 v2, v0, v2
    ds_read_b64_tr_b16 a[32:33], v18 offset:2048
    ds_read_b64_tr_b16 a[34:35], v18 offset:3072
    ds_read_b64_tr_b16 a[36:37], v19 offset:2048
    ds_read_b64_tr_b16 a[38:39], v19 offset:3072
    s_add_u32 m0, s4, 0
    s_add_u32 s85, s87, 65536
    buffer_load_dwordx4 v17, s[48:51], s85 offen lds
    buffer_load_dwordx4 v59, s[48:51], s85 offen offset:1024 lds
    buffer_load_dwordx4 v[24:27], v14, s[52:55], s86 offen offset:2048 sc1
    buffer_load_dwordx4 v[28:31], v14, s[52:55], s86 offen offset:3072 sc1
    s_waitcnt vmcnt(6)
    v_mfma_f32_32x32x16_bf16 v[64:79], a[40:43], v[32:35], v[64:79]
    v_and_b32 v6, 0xffff0000, v2
    v_lshlrev_b32 v2, 16, v2
    v_mfma_f32_32x32x16_bf16 v[80:95], a[44:47], v[32:35], v[80:95]
    v_lshlrev_b32 v0, 16, v3
    v_and_b32 v3, 0xffff0000, v3
    v_mfma_f32_32x32x16_bf16 v[96:111], a[40:43], v[36:39], v[96:111]
    v_lshlrev_b32 v10, 16, v7
    v_and_b32 v7, 0xffff0000, v7
    v_mfma_f32_32x32x16_bf16 v[112:127], a[44:47], v[36:39], v[112:127]
    v_mul_f32 v0, v0, v10
    v_mul_f32 v3, v3, v7
    ds_read_b64_tr_b16 a[40:41], v18 offset:4096
    ds_read_b64_tr_b16 a[42:43], v18 offset:5120
    ds_read_b64_tr_b16 a[44:45], v19 offset:4096
    ds_read_b64_tr_b16 a[46:47], v19 offset:5120
    s_waitcnt lgkmcnt(4)
    s_add_u32 m0, s4, 2048
    s_add_u32 s85, s87, 81920
    buffer_load_dwordx4 v17, s[48:51], s85 offen lds
    buffer_load_dwordx4 v59, s[48:51], s85 offen offset:1024 lds
    s_add_u32 s86, s22, 8192
    buffer_load_dwordx4 v[32:35], v14, s[52:55], s86 offen offset:0 sc1
    buffer_load_dwordx4 v[36:39], v14, s[52:55], s86 offen offset:1024 sc1
    s_waitcnt vmcnt(8)
    v_mfma_f32_32x32x16_bf16 v[64:79], a[48:51], v[40:43], v[64:79]
    v_cvt_pk_bf16_f32 v3, v0, v3
    v_and_b32 v7, 0xffff0000, v3
    v_mfma_f32_32x32x16_bf16 v[80:95], a[52:55], v[40:43], v[80:95]
    v_lshlrev_b32 v3, 16, v3
    v_lshlrev_b32 v0, 16, v4
    v_mfma_f32_32x32x16_bf16 v[96:111], a[48:51], v[44:47], v[96:111]
    v_and_b32 v4, 0xffff0000, v4
    v_lshlrev_b32 v10, 16, v8
    v_mfma_f32_32x32x16_bf16 v[112:127], a[52:55], v[44:47], v[112:127]
    v_and_b32 v8, 0xffff0000, v8
    v_mul_f32 v0, v0, v10
    ds_read_b64_tr_b16 a[48:49], v18 offset:6144
    ds_read_b64_tr_b16 a[50:51], v18 offset:7168
    ds_read_b64_tr_b16 a[52:53], v19 offset:6144
    ds_read_b64_tr_b16 a[54:55], v19 offset:7168
    s_waitcnt lgkmcnt(4)
    s_add_u32 m0, s4, 4096
    s_add_u32 s85, s87, 98304
    buffer_load_dwordx4 v17, s[48:51], s85 offen lds
    buffer_load_dwordx4 v59, s[48:51], s85 offen offset:1024 lds
    buffer_load_dwordx4 v[40:43], v14, s[52:55], s86 offen offset:2048 sc1
    buffer_load_dwordx4 v[44:47], v14, s[52:55], s86 offen offset:3072 sc1
    s_waitcnt vmcnt(8)
    v_mfma_f32_32x32x16_bf16 v[64:79], a[56:59], v[24:27], v[64:79]
    v_mul_f32 v4, v4, v8
    v_cvt_pk_bf16_f32 v4, v0, v4
    v_mfma_f32_32x32x16_bf16 v[80:95], a[60:63], v[24:27], v[80:95]
    v_and_b32 v8, 0xffff0000, v4
    v_lshlrev_b32 v4, 16, v4
    v_mfma_f32_32x32x16_bf16 v[96:111], a[56:59], v[28:31], v[96:111]
    v_lshlrev_b32 v0, 16, v5
    v_and_b32 v5, 0xffff0000, v5
    v_mfma_f32_32x32x16_bf16 v[112:127], a[60:63], v[28:31], v[112:127]
    v_lshlrev_b32 v10, 16, v9
    v_and_b32 v9, 0xffff0000, v9
    ds_read_b64_tr_b16 a[56:57], v18 offset:8192
    ds_read_b64_tr_b16 a[58:59], v18 offset:9216
    ds_read_b64_tr_b16 a[60:61], v19 offset:8192
    ds_read_b64_tr_b16 a[62:63], v19 offset:9216
    s_waitcnt lgkmcnt(4)
    s_add_u32 m0, s4, 6144
    s_add_u32 s85, s87, 114688
    buffer_load_dwordx4 v17, s[48:51], s85 offen lds
    buffer_load_dwordx4 v59, s[48:51], s85 offen offset:1024 lds
    s_add_u32 s86, s22, 12288
    buffer_load_dwordx4 v[24:27], v14, s[52:55], s86 offen offset:0 sc1
    buffer_load_dwordx4 v[28:31], v14, s[52:55], s86 offen offset:1024 sc1
    s_waitcnt vmcnt(8)
    v_mfma_f32_32x32x16_bf16 v[64:79], a[64:67], v[32:35], v[64:79]
    v_mul_f32 v0, v0, v10
    v_mul_f32 v5, v5, v9
    v_mfma_f32_32x32x16_bf16 v[80:95], a[68:71], v[32:35], v[80:95]
    v_cvt_pk_bf16_f32 v5, v0, v5
    v_and_b32 v9, 0xffff0000, v5
    v_mfma_f32_32x32x16_bf16 v[96:111], a[64:67], v[36:39], v[96:111]
    v_lshlrev_b32 v5, 16, v5
    v_mfma_f32_32x32x16_bf16 v[112:127], a[68:71], v[36:39], v[112:127]
    ds_read_b64_tr_b16 a[64:65], v18 offset:0
    ds_read_b64_tr_b16 a[66:67], v18 offset:1024
    ds_read_b64_tr_b16 a[68:69], v19 offset:0
    ds_read_b64_tr_b16 a[70:71], v19 offset:1024
    s_waitcnt lgkmcnt(4)
    s_add_u32 m0, s4, 8192
    s_add_u32 s85, s87, 131072
    buffer_load_dwordx4 v17, s[48:51], s85 offen lds
    buffer_load_dwordx4 v59, s[48:51], s85 offen offset:1024 lds
    buffer_load_dwordx4 v[32:35], v14, s[52:55], s86 offen offset:2048 sc1
    buffer_load_dwordx4 v[36:39], v14, s[52:55], s86 offen offset:3072 sc1
    s_waitcnt vmcnt(8)
    v_mfma_f32_32x32x16_bf16 v[64:79], a[72:75], v[40:43], v[64:79]
    v_mfma_f32_32x32x16_bf16 v[80:95], a[76:79], v[40:43], v[80:95]
    v_mfma_f32_32x32x16_bf16 v[96:111], a[72:75], v[44:47], v[96:111]
    v_mfma_f32_32x32x16_bf16 v[112:127], a[76:79], v[44:47], v[112:127]
    ds_read_b64_tr_b16 a[72:73], v18 offset:2048
    ds_read_b64_tr_b16 a[74:75], v18 offset:3072
    ds_read_b64_tr_b16 a[76:77], v19 offset:2048
    ds_read_b64_tr_b16 a[78:79], v19 offset:3072
    s_waitcnt lgkmcnt(4)
    s_add_u32 m0, s4, 0
    s_add_u32 s85, s87, 147456
    buffer_load_dwordx4 v17, s[48:51], s85 offen lds
    buffer_load_dwordx4 v59, s[48:51], s85 offen offset:1024 lds
    s_add_u32 s86, s22, 16384
    buffer_load_dwordx4 v[40:43], v14, s[52:55], s86 offen offset:0 sc1
    buffer_load_dwordx4 v[44:47], v14, s[52:55], s86 offen offset:1024 sc1
    s_waitcnt vmcnt(8)
    v_mfma_f32_32x32x16_bf16 v[64:79], a[80:83], v[24:27], v[64:79]
    v_mfma_f32_32x32x16_bf16 v[80:95], a[84:87], v[24:27], v[80:95]
    v_mfma_f32_32x32x16_bf16 v[96:111], a[80:83], v[28:31], v[96:111]
    v_mfma_f32_32x32x16_bf16 v[112:127], a[84:87], v[28:31], v[112:127]
    ds_read_b64_tr_b16 a[80:81], v18 offset:4096
    ds_read_b64_tr_b16 a[82:83], v18 offset:5120
    ds_read_b64_tr_b16 a[84:85], v19 offset:4096
    ds_read_b64_tr_b16 a[86:87], v19 offset:5120
    s_waitcnt lgkmcnt(4)
    s_add_u32 m0, s4, 2048
    s_add_u32 s85, s87, 163840
    buffer_load_dwordx4 v17, s[48:51], s85 offen lds
    buffer_load_dwordx4 v59, s[48:51], s85 offen offset:1024 lds
    buffer_load_dwordx4 v[24:27], v14, s[52:55], s86 offen offset:2048 sc1
    buffer_load_dwordx4 v[28:31], v14, s[52:55], s86 offen offset:3072 sc1
    s_waitcnt vmcnt(8)
    v_mfma_f32_32x32x16_bf16 v[64:79], a[88:91], v[32:35], v[64:79]
    v_mfma_f32_32x32x16_bf16 v[80:95], a[92:95], v[32:35], v[80:95]
    v_mfma_f32_32x32x16_bf16 v[96:111], a[88:91], v[36:39], v[96:111]
    v_mfma_f32_32x32x16_bf16 v[112:127], a[92:95], v[36:39], v[112:127]
    ds_read_b64_tr_b16 a[88:89], v18 offset:6144
    ds_read_b64_tr_b16 a[90:91], v18 offset:7168
    ds_read_b64_tr_b16 a[92:93], v19 offset:6144
    ds_read_b64_tr_b16 a[94:95], v19 offset:7168
    s_waitcnt lgkmcnt(4)
    s_add_u32 m0, s4, 4096
    s_add_u32 s85, s87, 180224
    buffer_load_dwordx4 v17, s[48:51], s85 offen lds
    buffer_load_dwordx4 v59, s[48:51], s85 offen offset:1024 lds
    s_add_u32 s86, s22, 20480
    buffer_load_dwordx4 v[32:35], v14, s[52:55], s86 offen offset:0 sc1
    buffer_load_dwordx4 v[36:39], v14, s[52:55], s86 offen offset:1024 sc1
    s_waitcnt vmcnt(8)
    v_mfma_f32_32x32x16_bf16 v[64:79], a[96:99], v[40:43], v[64:79]
    v_mfma_f32_32x32x16_bf16 v[80:95], a[100:103], v[40:43], v[80:95]
    v_mfma_f32_32x32x16_bf16 v[96:111], a[96:99], v[44:47], v[96:111]
    v_mfma_f32_32x32x16_bf16 v[112:127], a[100:103], v[44:47], v[112:127]
    ds_read_b64_tr_b16 a[96:97], v18 offset:8192
    ds_read_b64_tr_b16 a[98:99], v18 offset:9216
    ds_read_b64_tr_b16 a[100:101], v19 offset:8192
    ds_read_b64_tr_b16 a[102:103], v19 offset:9216
    buffer_load_dwordx4 v[40:43], v14, s[52:55], s86 offen offset:2048 sc1
    buffer_load_dwordx4 v[44:47], v14, s[52:55], s86 offen offset:3072 sc1
    s_waitcnt vmcnt(6)
    v_mfma_f32_32x32x16_bf16 v[64:79], a[104:107], v[24:27], v[64:79]
    v_mfma_f32_32x32x16_bf16 v[80:95], a[108:111], v[24:27], v[80:95]
    v_mfma_f32_32x32x16_bf16 v[96:111], a[104:107], v[28:31], v[96:111]
    v_mfma_f32_32x32x16_bf16 v[112:127], a[108:111], v[28:31], v[112:127]
    ds_read_b64_tr_b16 a[104:105], v18 offset:0
    ds_read_b64_tr_b16 a[106:107], v18 offset:1024
    ds_read_b64_tr_b16 a[108:109], v19 offset:0
    ds_read_b64_tr_b16 a[110:111], v19 offset:1024
    s_lshr_b32 s99, s26, 1
    s_lshl_b32 s99, s99, 7
    s_add_u32 s99, s99, 0x1141800
    v_and_b32 v63, 15, v1
    v_lshl_add_u32 v62, v63, 3, s99
    buffer_load_dwordx2 v[60:61], v62, s[64:67], 0 offen sc1
    s_add_u32 s86, s22, 24576
    buffer_load_dwordx4 v[24:27], v14, s[52:55], s86 offen offset:0 sc1
    buffer_load_dwordx4 v[28:31], v14, s[52:55], s86 offen offset:1024 sc1
    s_waitcnt vmcnt(5)
    v_mfma_f32_32x32x16_bf16 v[64:79], a[112:115], v[32:35], v[64:79]
    v_mfma_f32_32x32x16_bf16 v[80:95], a[116:119], v[32:35], v[80:95]
    v_mfma_f32_32x32x16_bf16 v[96:111], a[112:115], v[36:39], v[96:111]
    v_mfma_f32_32x32x16_bf16 v[112:127], a[116:119], v[36:39], v[112:127]
    ds_read_b64_tr_b16 a[112:113], v18 offset:2048
    ds_read_b64_tr_b16 a[114:115], v18 offset:3072
    ds_read_b64_tr_b16 a[116:117], v19 offset:2048
    ds_read_b64_tr_b16 a[118:119], v19 offset:3072
    buffer_load_dwordx4 v[32:35], v14, s[52:55], s86 offen offset:2048 sc1
    buffer_load_dwordx4 v[36:39], v14, s[52:55], s86 offen offset:3072 sc1
    s_waitcnt vmcnt(5)
    v_mfma_f32_32x32x16_bf16 v[64:79], a[120:123], v[40:43], v[64:79]
    v_mfma_f32_32x32x16_bf16 v[80:95], a[124:127], v[40:43], v[80:95]
    v_mfma_f32_32x32x16_bf16 v[96:111], a[120:123], v[44:47], v[96:111]
    v_mfma_f32_32x32x16_bf16 v[112:127], a[124:127], v[44:47], v[112:127]
    ds_read_b64_tr_b16 a[120:121], v18 offset:4096
    ds_read_b64_tr_b16 a[122:123], v18 offset:5120
    ds_read_b64_tr_b16 a[124:125], v19 offset:4096
    ds_read_b64_tr_b16 a[126:127], v19 offset:5120
    s_add_u32 s86, s22, 28672
    buffer_load_dwordx4 v[40:43], v14, s[52:55], s86 offen offset:0 sc1
    buffer_load_dwordx4 v[44:47], v14, s[52:55], s86 offen offset:1024 sc1
    s_waitcnt vmcnt(4)
    v_mfma_f32_32x32x16_bf16 v[64:79], a[0:3], v[24:27], v[64:79]
    v_mfma_f32_32x32x16_bf16 v[80:95], a[4:7], v[24:27], v[80:95]
    v_mfma_f32_32x32x16_bf16 v[96:111], a[0:3], v[28:31], v[96:111]
    v_mfma_f32_32x32x16_bf16 v[112:127], a[4:7], v[28:31], v[112:127]
    buffer_load_dwordx4 v[24:27], v14, s[52:55], s86 offen offset:2048 sc1
    buffer_load_dwordx4 v[28:31], v14, s[52:55], s86 offen offset:3072 sc1
    s_waitcnt vmcnt(4)
    v_mfma_f32_32x32x16_bf16 v[64:79], a[8:11], v[32:35], v[64:79]
    v_mfma_f32_32x32x16_bf16 v[80:95], a[12:15], v[32:35], v[80:95]
    v_mfma_f32_32x32x16_bf16 v[96:111], a[8:11], v[36:39], v[96:111]
    v_mfma_f32_32x32x16_bf16 v[112:127], a[12:15], v[36:39], v[112:127]
    s_mov_b32 s93, 0x40000
K1_FCHK12:
    v_cmp_ne_u64 s[0:1], v[60:61], s[12:13]
    s_sub_u32 s93, s93, 1
    s_cmp_eq_u32 s93, 0
    s_cbranch_scc1 K1_FOK13
    s_cmp_eq_u64 s[0:1], 0
    s_cbranch_scc1 K1_FOK13
    s_sleep 1
    buffer_load_dwordx2 v[60:61], v62, s[64:67], 0 offen sc1
    s_waitcnt vmcnt(0)
    s_branch K1_FCHK12
K1_FOK13:
    s_add_u32 s86, s23, 0
    buffer_load_dwordx4 v[32:35], v14, s[52:55], s86 offen offset:0 sc1
    buffer_load_dwordx4 v[36:39], v14, s[52:55], s86 offen offset:1024 sc1
    s_waitcnt vmcnt(4)
    v_mfma_f32_32x32x16_bf16 v[64:79], a[16:19], v[40:43], v[64:79]
    v_mfma_f32_32x32x16_bf16 v[80:95], a[20:23], v[40:43], v[80:95]
    v_mfma_f32_32x32x16_bf16 v[96:111], a[16:19], v[44:47], v[96:111]
    v_mfma_f32_32x32x16_bf16 v[112:127], a[20:23], v[44:47], v[112:127]
    buffer_load_dwordx4 v[40:43], v14, s[52:55], s86 offen offset:2048 sc1
    buffer_load_dwordx4 v[44:47], v14, s[52:55], s86 offen offset:3072 sc1
    s_waitcnt vmcnt(4)
    v_mfma_f32_32x32x16_bf16 v[64:79], a[24:27], v[24:27], v[64:79]
    v_mfma_f32_32x32x16_bf16 v[80:95], a[28:31], v[24:27], v[80:95]
    v_mfma_f32_32x32x16_bf16 v[96:111], a[24:27], v[28:31], v[96:111]
    v_mfma_f32_32x32x16_bf16 v[112:127], a[28:31], v[28:31], v[112:127]
    s_add_u32 s86, s23, 4096
    buffer_load_dwordx4 v[24:27], v14, s[52:55], s86 offen offset:0 sc1
    buffer_load_dwordx4 v[28:31], v14, s[52:55], s86 offen offset:1024 sc1
    s_waitcnt vmcnt(4)
    v_mfma_f32_32x32x16_bf16 v[64:79], a[32:35], v[32:35], v[64:79]
    v_mfma_f32_32x32x16_bf16 v[80:95], a[36:39], v[32:35], v[80:95]
    v_mfma_f32_32x32x16_bf16 v[96:111], a[32:35], v[36:39], v[96:111]
    v_mfma_f32_32x32x16_bf16 v[112:127], a[36:39], v[36:39], v[112:127]
    buffer_load_dwordx4 v[32:35], v14, s[52:55], s86 offen offset:2048 sc1
    buffer_load_dwordx4 v[36:39], v14, s[52:55], s86 offen offset:3072 sc1
    s_waitcnt vmcnt(4)
    v_mfma_f32_32x32x16_bf16 v[64:79], a[40:43], v[40:43], v[64:79]
    v_mfma_f32_32x32x16_bf16 v[80:95], a[44:47], v[40:43], v[80:95]
    v_mfma_f32_32x32x16_bf16 v[96:111], a[40:43], v[44:47], v[96:111]
    v_mfma_f32_32x32x16_bf16 v[112:127], a[44:47], v[44:47], v[112:127]
    s_add_u32 s86, s23, 8192
    buffer_load_dwordx4 v[40:43], v14, s[52:55], s86 offen offset:0 sc1
    buffer_load_dwordx4 v[44:47], v14, s[52:55], s86 offen offset:1024 sc1
    s_waitcnt vmcnt(4)
    v_mfma_f32_32x32x16_bf16 v[64:79], a[48:51], v[24:27], v[64:79]
    v_mfma_f32_32x32x16_bf16 v[80:95], a[52:55], v[24:27], v[80:95]
    v_mfma_f32_32x32x16_bf16 v[96:111], a[48:51], v[28:31], v[96:111]
    v_mfma_f32_32x32x16_bf16 v[112:127], a[52:55], v[28:31], v[112:127]
    buffer_load_dwordx4 v[24:27], v14, s[52:55], s86 offen offset:2048 sc1
    buffer_load_dwordx4 v[28:31], v14, s[52:55], s86 offen offset:3072 sc1
    s_waitcnt vmcnt(4)
    v_mfma_f32_32x32x16_bf16 v[64:79], a[56:59], v[32:35], v[64:79]
    v_mfma_f32_32x32x16_bf16 v[80:95], a[60:63], v[32:35], v[80:95]
    v_mfma_f32_32x32x16_bf16 v[96:111], a[56:59], v[36:39], v[96:111]
    v_mfma_f32_32x32x16_bf16 v[112:127], a[60:63], v[36:39], v[112:127]
    s_add_u32 s86, s23, 12288
    buffer_load_dwordx4 v[32:35], v14, s[52:55], s86 offen offset:0 sc1
    buffer_load_dwordx4 v[36:39], v14, s[52:55], s86 offen offset:1024 sc1
    s_waitcnt vmcnt(4)
    v_mfma_f32_32x32x16_bf16 v[64:79], a[64:67], v[40:43], v[64:79]
    v_mfma_f32_32x32x16_bf16 v[80:95], a[68:71], v[40:43], v[80:95]
    v_mfma_f32_32x32x16_bf16 v[96:111], a[64:67], v[44:47], v[96:111]
    v_mfma_f32_32x32x16_bf16 v[112:127], a[68:71], v[44:47], v[112:127]
    buffer_load_dwordx4 v[40:43], v14, s[52:55], s86 offen offset:2048 sc1
    buffer_load_dwordx4 v[44:47], v14, s[52:55], s86 offen offset:3072 sc1
    s_waitcnt vmcnt(4)
    v_mfma_f32_32x32x16_bf16 v[64:79], a[72:75], v[24:27], v[64:79]
    v_mfma_f32_32x32x16_bf16 v[80:95], a[76:79], v[24:27], v[80:95]
    v_mfma_f32_32x32x16_bf16 v[96:111], a[72:75], v[28:31], v[96:111]
    v_mfma_f32_32x32x16_bf16 v[112:127], a[76:79], v[28:31], v[112:127]
    s_add_u32 s86, s23, 16384
    buffer_load_dwordx4 v[24:27], v14, s[52:55], s86 offen offset:0 sc1
    buffer_load_dwordx4 v[28:31], v14, s[52:55], s86 offen offset:1024 sc1
    s_waitcnt vmcnt(4)
    v_mfma_f32_32x32x16_bf16 v[64:79], a[80:83], v[32:35], v[64:79]
    v_mfma_f32_32x32x16_bf16 v[80:95], a[84:87], v[32:35], v[80:95]
    v_mfma_f32_32x32x16_bf16 v[96:111], a[80:83], v[36:39], v[96:111]
    v_mfma_f32_32x32x16_bf16 v[112:127], a[84:87], v[36:39], v[112:127]
    buffer_load_dwordx4 v[32:35], v14, s[52:55], s86 offen offset:2048 sc1
    buffer_load_dwordx4 v[36:39], v14, s[52:55], s86 offen offset:3072 sc1
    s_waitcnt lgkmcnt(15)
    s_waitcnt vmcnt(4)
    v_mfma_f32_32x32x16_bf16 v[64:79], a[88:91], v[40:43], v[64:79]
    v_mfma_f32_32x32x16_bf16 v[80:95], a[92:95], v[40:43], v[80:95]
    v_mfma_f32_32x32x16_bf16 v[96:111], a[88:91], v[44:47], v[96:111]
    v_mfma_f32_32x32x16_bf16 v[112:127], a[92:95], v[44:47], v[112:127]
    s_add_u32 s86, s23, 20480
    buffer_load_dwordx4 v[40:43], v14, s[52:55], s86 offen offset:0 sc1
    buffer_load_dwordx4 v[44:47], v14, s[52:55], s86 offen offset:1024 sc1
    s_waitcnt lgkmcnt(12)
    s_waitcnt vmcnt(4)
    v_mfma_f32_32x32x16_bf16 v[64:79], a[96:99], v[24:27], v[64:79]
    v_mfma_f32_32x32x16_bf16 v[80:95], a[100:103], v[24:27], v[80:95]
    v_mfma_f32_32x32x16_bf16 v[96:111], a[96:99], v[28:31], v[96:111]
    v_mfma_f32_32x32x16_bf16 v[112:127], a[100:103], v[28:31], v[112:127]
    buffer_load_dwordx4 v[24:27], v14, s[52:55], s86 offen offset:2048 sc1
    buffer_load_dwordx4 v[28:31], v14, s[52:55], s86 offen offset:3072 sc1
    s_waitcnt lgkmcnt(8)
    s_waitcnt vmcnt(4)
    v_mfma_f32_32x32x16_bf16 v[64:79], a[104:107], v[32:35], v[64:79]
    v_mfma_f32_32x32x16_bf16 v[80:95], a[108:111], v[32:35], v[80:95]
    v_mfma_f32_32x32x16_bf16 v[96:111], a[104:107], v[36:39], v[96:111]
    v_mfma_f32_32x32x16_bf16 v[112:127], a[108:111], v[36:39], v[112:127]
    s_waitcnt lgkmcnt(4)
    s_waitcnt vmcnt(2)
    v_mfma_f32_32x32x16_bf16 v[64:79], a[112:115], v[40:43], v[64:79]
    v_mfma_f32_32x32x16_bf16 v[80:95], a[116:119], v[40:43], v[80:95]
    v_mfma_f32_32x32x16_bf16 v[96:111], a[112:115], v[44:47], v[96:111]
    v_mfma_f32_32x32x16_bf16 v[112:127], a[116:119], v[44:47], v[112:127]
    s_waitcnt lgkmcnt(0)
    s_waitcnt vmcnt(0)
    v_mfma_f32_32x32x16_bf16 v[64:79], a[120:123], v[24:27], v[64:79]
    v_mfma_f32_32x32x16_bf16 v[80:95], a[124:127], v[24:27], v[80:95]
    v_mfma_f32_32x32x16_bf16 v[96:111], a[120:123], v[28:31], v[96:111]
    v_mfma_f32_32x32x16_bf16 v[112:127], a[124:127], v[28:31], v[112:127]
    v_mov_b32 v24, 162052
K1_CNT214:
    ds_read_b32 v25, v24
    s_waitcnt lgkmcnt(0)
    v_readfirstlane_b32 s99, v25
    s_cmp_lt_u32 s99, 4
    s_cbranch_scc1 K1_CNT214
    s_nop 5
    ds_write_b128 v15, v[64:67] offset:0
    ds_write_b128 v15, v[68:71] offset:1024
    ds_write_b128 v15, v[72:75] offset:2048
    ds_write_b128 v15, v[76:79] offset:3072
    ds_write_b128 v15, v[80:83] offset:4096
    ds_write_b128 v15, v[84:87] offset:5120
    ds_write_b128 v15, v[88:91] offset:6144
    ds_write_b128 v15, v[92:95] offset:7168
    ds_write_b128 v15, v[96:99] offset:8192
    ds_write_b128 v15, v[100:103] offset:9216
    ds_write_b128 v15, v[104:107] offset:10240
    ds_write_b128 v15, v[108:111] offset:11264
    ds_write_b128 v15, v[112:115] offset:12288
    ds_write_b128 v15, v[116:119] offset:13312
    ds_write_b128 v15, v[120:123] offset:14336
    ds_write_b128 v15, v[124:127] offset:15360
K1_EPI:
    s_mov_b32 s99, 0x1000000
    buffer_load_dwordx2 v[10:11], v13, s[64:67], s99 offen sc1
    s_lshl_b32 s99, s42, 12
    s_lshl_b32 s100, s43, 11
    s_add_u32 s99, s99, s100
    v_add_u32 v24, s99, v14
    v_add_u32 v25, 81920, v24
    s_nop 5
    s_barrier
    s_cmp_eq_u32 s43, 0
    s_cbranch_scc0 K1_WROTE
    ds_write_b128 v15, v[64:67] offset:0
    ds_write_b128 v15, v[68:71] offset:1024
    ds_write_b128 v15, v[72:75] offset:2048
    ds_write_b128 v15, v[76:79] offset:3072
    ds_write_b128 v15, v[80:83] offset:4096
    ds_write_b128 v15, v[84:87] offset:5120
    ds_write_b128 v15, v[88:91] offset:6144
    ds_write_b128 v15, v[92:95] offset:7168
    ds_write_b128 v15, v[96:99] offset:8192
    ds_write_b128 v15, v[100:103] offset:9216
    ds_write_b128 v15, v[104:107] offset:10240
    ds_write_b128 v15, v[108:111] offset:11264
    ds_write_b128 v15, v[112:115] offset:12288
    ds_write_b128 v15, v[116:119] offset:13312
    ds_write_b128 v15, v[120:123] offset:14336
    ds_write_b128 v15, v[124:127] offset:15360
K1_WROTE:
    s_waitcnt lgkmcnt(0)
    s_barrier
    ds_read_b128 v[64:67], v24 offset:16384
    ds_read_b128 v[68:71], v24 offset:57344
    ds_read_b128 v[72:75], v25 offset:16384
    ds_read_b128 v[76:79], v25 offset:57344
    ds_read_b128 v[80:83], v24 offset:0
    ds_read_b128 v[84:87], v24 offset:40960
    ds_read_b128 v[88:91], v25 offset:0
    ds_read_b128 v[92:95], v25 offset:40960
    ds_read_b128 v[96:99], v24 offset:17408
    ds_read_b128 v[100:103], v24 offset:58368
    ds_read_b128 v[104:107], v25 offset:17408
    ds_read_b128 v[108:111], v25 offset:58368
    ds_read_b128 v[112:115], v24 offset:1024
    ds_read_b128 v[116:119], v24 offset:41984
    ds_read_b128 v[120:123], v25 offset:1024
    ds_read_b128 v[124:127], v25 offset:41984
    s_waitcnt lgkmcnt(8)
    v_add_f32 v64, v64, v68
    v_add_f32 v72, v72, v76
    v_add_f32 v80, v80, v84
    v_add_f32 v88, v88, v92
    v_add_f32 v65, v65, v69
    v_add_f32 v73, v73, v77
    v_add_f32 v81, v81, v85
    v_add_f32 v89, v89, v93
    v_add_f32 v66, v66, v70
    v_add_f32 v74, v74, v78
    v_add_f32 v82, v82, v86
    v_add_f32 v90, v90, v94
    v_add_f32 v67, v67, v71
    v_add_f32 v75, v75, v79
    v_add_f32 v83, v83, v87
    v_add_f32 v91, v91, v95
    v_add_f32 v64, v64, v2
    v_add_f32 v80, v80, v88
    v_add_f32 v65, v65, v6
    v_add_f32 v81, v81, v89
    v_add_f32 v66, v66, v3
    v_add_f32 v82, v82, v90
    v_add_f32 v67, v67, v7
    v_add_f32 v83, v83, v91
    v_add_f32 v64, v64, v72
    v_add_f32 v65, v65, v73
    v_add_f32 v66, v66, v74
    v_add_f32 v67, v67, v75
    s_waitcnt vmcnt(0)
    v_mul_f32 v64, v64, v10
    v_mul_f32 v65, v65, v10
    v_mul_f32 v66, v66, v10
    v_mul_f32 v67, v67, v10
    v_fmac_f32 v64, v80, v11
    v_fmac_f32 v65, v81, v11
    v_fmac_f32 v66, v82, v11
    v_fmac_f32 v67, v83, v11
    buffer_store_dwordx4 v[64:67], v12, s[56:59], 0 offen offset:0
    s_waitcnt lgkmcnt(0)
    v_add_f32 v96, v96, v100
    v_add_f32 v104, v104, v108
    v_add_f32 v112, v112, v116
    v_add_f32 v120, v120, v124
    v_add_f32 v97, v97, v101
    v_add_f32 v105, v105, v109
    v_add_f32 v113, v113, v117
    v_add_f32 v121, v121, v125
    v_add_f32 v98, v98, v102
    v_add_f32 v106, v106, v110
    v_add_f32 v114, v114, v118
    v_add_f32 v122, v122, v126
    v_add_f32 v99, v99, v103
    v_add_f32 v107, v107, v111
    v_add_f32 v115, v115, v119
    v_add_f32 v123, v123, v127
    v_add_f32 v96, v96, v4
    v_add_f32 v112, v112, v120
    v_add_f32 v97, v97, v8
    v_add_f32 v113, v113, v121
    v_add_f32 v98, v98, v5
    v_add_f32 v114, v114, v122
    v_add_f32 v99, v99, v9
    v_add_f32 v115, v115, v123
    v_add_f32 v96, v96, v104
    v_add_f32 v97, v97, v105
    v_add_f32 v98, v98, v106
    v_add_f32 v99, v99, v107
    v_mul_f32 v96, v96, v10
    v_mul_f32 v97, v97, v10
    v_mul_f32 v98, v98, v10
    v_mul_f32 v99, v99, v10
    v_fmac_f32 v96, v112, v11
    v_fmac_f32 v97, v113, v11
    v_fmac_f32 v98, v114, v11
    v_fmac_f32 v99, v115, v11
    buffer_store_dwordx4 v[96:99], v12, s[56:59], 0 offen offset:32
K1_END:
    s_endpgm
.section .rodata,"a"
.p2align 6
.amdhsa_kernel gated_mix__ssm_conv_s5__glu_gated_glu__prompt_kernel
  .amdhsa_next_free_vgpr 256
  .amdhsa_next_free_sgpr 102
  .amdhsa_accum_offset 128
  .amdhsa_group_segment_fixed_size 0
  .amdhsa_kernarg_size 136
  .amdhsa_user_sgpr_count 2
  .amdhsa_user_sgpr_kernarg_segment_ptr 1
  .amdhsa_system_sgpr_workgroup_id_x 1
.end_amdhsa_kernel
```
